```python
import torch

def _softmax(x, axis=-1):
    return torch.softmax(x, dim=axis)
def _gelu(x):
    return torch.nn.functional.gelu(x, approximate="tanh")
def _silu(x):
    return torch.nn.functional.silu(x)
def _sigmoid(x):
    return torch.sigmoid(x)
def _layernorm(x, axis=-1, eps=1e-5):
    m = x.mean(dim=axis, keepdim=True)
    v = x.var(dim=axis, keepdim=True, unbiased=False)
    return (x - m) / torch.sqrt(v + eps)
def _scatter_add(tgt, idx, src, axis=0):
    return tgt.clone().index_add_(axis, idx, src)
def _segment_sum(src, seg, n):
    out = torch.zeros((n,) + src.shape[1:], dtype=src.dtype)
    return out.index_add_(0, seg, src)
def _pad(x, pw):
    flat = tuple(v for pair in reversed(pw) for v in pair)
    return torch.nn.functional.pad(x, flat)

kernel_name = 'sequential_preLN__ssm_conv_h3__mixer_token_mlp__prompt'

def setup_inputs():

    _w = (lambda a: (lambda t: t.to(torch.bfloat16) if t.is_floating_point() else t)(torch.as_tensor(a)))
    def _A_setup():
        B, S, D = 1, 2048, 448
        ks = 4
        return {
            "q": _w((lambda *s: torch.randn(*s, dtype=torch.bfloat16) * 0.05)(B, S, D)),
            "k": _w((lambda *s: torch.randn(*s, dtype=torch.bfloat16) * 0.2)(B, S, D)),
            "v": _w((lambda *s: torch.randn(*s, dtype=torch.bfloat16) * 0.2)(B, S, D)),
            "shift_k": _w((lambda *s: torch.randn(*s, dtype=torch.bfloat16) * 0.2)(D, ks) * 0.5),
            "ssm_k": _w((lambda *s: torch.randn(*s, dtype=torch.bfloat16) * 0.4)(D, S) * (1.0 / S ** 0.5)),
            "ssm_D": _w((lambda *s: torch.randn(*s, dtype=torch.bfloat16) * 0.2)(D)),
        }
    _A_in = _A_setup()

    def _B_setup():
        B, S, D, F = 1, 2048, 448, 1792
        return {
            "x": _w((lambda *s: torch.randn(*s, dtype=torch.bfloat16) * 0.05)(B, S, D)),
            "w1": _w((lambda *s: torch.randn(*s, dtype=torch.bfloat16) * 0.4)(S, F) * (S ** -0.5)),
            "b1": _w((lambda *s: torch.randn(*s, dtype=torch.bfloat16) * 3.2)(F) * 0.02),
            "w2": _w((lambda *s: torch.randn(*s, dtype=torch.bfloat16) * 0.2)(F, S) * (F ** -0.5)),
            "b2": _w((lambda *s: torch.randn(*s, dtype=torch.bfloat16) * 0.4)(S) * 0.02),
        }
    _B_in = _B_setup()

    return {
        "A_q": _A_in["q"],
        "A_k": _A_in["k"],
        "A_v": _A_in["v"],
        "A_shift_k": _A_in["shift_k"],
        "A_ssm_k": _A_in["ssm_k"],
        "A_ssm_D": _A_in["ssm_D"],
        "B_x": _B_in["x"],
        "B_w1": _B_in["w1"],
        "B_b1": _B_in["b1"],
        "B_w2": _B_in["w2"],
        "B_b2": _B_in["b2"],
    }

def reference(A_q, A_k, A_v, A_shift_k, A_ssm_k, A_ssm_D, B_x, B_w1, B_b1, B_w2, B_b2):
    def _A_ref(q, k, v, shift_k, ssm_k, ssm_D):
        B, S, D = q.shape
        ks = shift_k.shape[-1]
        k_pad = _pad(k, ((0, 0), (ks - 1, 0), (0, 0)))
        k_shift = torch.zeros_like(k)
        for t in range(ks):
            k_shift = k_shift + k_pad[:, t:t + S, :] * shift_k[:, ks - 1 - t][None, None, :]
        kv = k_shift * v
        L = 2 * S
        kv_pad = _pad(kv, ((0, 0), (0, S), (0, 0)))
        kf_pad = _pad(ssm_k, ((0, 0), (0, S)))
        kv_f = (lambda x, axes=(-2,-1): torch.fft.rfft2(x.float(), dim=axes))(kv_pad[:, None, :, :], axes=(1, 2))
        kf_f = (lambda x, axes=(-2,-1): torch.fft.rfft2(x.float(), dim=axes))(kf_pad[:, None, :], axes=(1, 2))
        kf_f = (lambda x, *d: x.permute(*d))(kf_f, 1, 2, 0)
        y_f = kv_f * kf_f[None, :, :, :]
        y = (lambda x, s, axes=(-2,-1): torch.fft.irfft2(x, s=s, dim=axes).to(torch.bfloat16))(y_f, (1, L), axes=(1, 2))[:, 0, :S, :]
        y = y + kv * ssm_D[None, None, :]
        return q * y

    def _B_ref(x, w1, b1, w2, b2):
        B, S, D = x.shape
        h = _layernorm(x, axis=-1)
        u = torch.einsum("bsd,sf->bdf", h, w1) + b1
        u = _gelu(u)
        y = torch.einsum("bdf,fs->bds", u, w2) + b2
        return (lambda x, *d: x.permute(*d))(y, 0, 2, 1)

    x = A_q
    h = x + _A_ref(_layernorm(x, axis=-1), A_k, A_v, A_shift_k, A_ssm_k, A_ssm_D)
    h2 = h + _B_ref(_layernorm(h, axis=-1), B_w1, B_b1, B_w2, B_b2)
    return h2
```

```asm
; @launch grid=(256,1,1) block=(256,1,1) lds=163840
.amdgcn_target "amdgcn-amd-amdhsa--gfx950"
.text
.globl sequential_preLN__ssm_conv_h3__mixer_token_mlp__prompt_kernel
.p2align 8
.type sequential_preLN__ssm_conv_h3__mixer_token_mlp__prompt_kernel,@function
sequential_preLN__ssm_conv_h3__mixer_token_mlp__prompt_kernel:
s_cmp_ge_u32 s2, 256
s_cbranch_scc1 L_exit
s_load_dwordx2 s[8:9], s[0:1], 8
s_load_dwordx2 s[12:13], s[0:1], 16
s_load_dwordx2 s[16:17], s[0:1], 24
s_load_dwordx2 s[48:49], s[0:1], 104
s_and_b32 s55, s2, 7
s_lshr_b32 s56, s2, 3
s_lshl_b32 s67, s55, 5
s_add_u32 s67, s67, s56
s_mov_b32 s10, 0x1c0000
s_mov_b32 s11, 0x20000
s_mov_b32 s14, 0x1c0000
s_mov_b32 s15, 0x20000
s_mov_b32 s18, 0xe00
s_mov_b32 s19, 0x20000
s_mov_b32 s50, 0x1000000
s_mov_b32 s51, 0x20000
s_mul_i32 s60, s67, 7168
v_lshlrev_b32 v2, 2, v0
v_add_u32 v3, s60, v2
v_mov_b32 v4, 0x80000000
v_cmp_gt_u32 vcc, 224, v0
v_lshlrev_b32 v7, 4, v0
s_nop 0
v_cndmask_b32 v3, v4, v3, vcc
v_add_u32 v5, 4480, v3
v_subrev_u32 v6, 2688, v3
s_cmp_eq_u32 s67, 0
s_cselect_b32 s61, 1, 0
v_mov_b32 v19, s61
v_cmp_eq_u32 vcc, 1, v19
v_mov_b32 v19, 0
s_nop 0
v_cndmask_b32 v6, v6, v4, vcc
s_waitcnt lgkmcnt(0)
buffer_load_dword v8, v6, s[8:11], 0 offen offset:0 nt
buffer_load_dword v9, v6, s[8:11], 0 offen offset:896 nt
buffer_load_dword v10, v6, s[8:11], 0 offen offset:1792 nt
buffer_load_dword v11, v3, s[8:11], 0 offen offset:0 nt
buffer_load_dword v12, v3, s[8:11], 0 offen offset:896 nt
buffer_load_dword v13, v3, s[8:11], 0 offen offset:1792 nt
buffer_load_dword v14, v3, s[8:11], 0 offen offset:2688 nt
buffer_load_dword v15, v3, s[8:11], 0 offen offset:3584 nt
buffer_load_dword v16, v5, s[8:11], 0 offen offset:0 nt
buffer_load_dword v17, v5, s[8:11], 0 offen offset:896 nt
buffer_load_dword v18, v5, s[8:11], 0 offen offset:1792 nt
buffer_load_dword v20, v3, s[12:15], 0 offen offset:0 nt
buffer_load_dword v21, v3, s[12:15], 0 offen offset:896 nt
buffer_load_dword v22, v3, s[12:15], 0 offen offset:1792 nt
buffer_load_dword v23, v3, s[12:15], 0 offen offset:2688 nt
buffer_load_dword v24, v3, s[12:15], 0 offen offset:3584 nt
buffer_load_dword v25, v5, s[12:15], 0 offen offset:0 nt
buffer_load_dword v26, v5, s[12:15], 0 offen offset:896 nt
buffer_load_dword v27, v5, s[12:15], 0 offen offset:1792 nt
buffer_load_dwordx4 v[36:39], v7, s[16:19], 0 offen
buffer_load_dword v41, v19, s[48:51], 0 offen sc1
s_load_dwordx2 s[20:21], s[0:1], 32
s_load_dwordx2 s[4:5], s[0:1], 0
s_load_dwordx2 s[24:25], s[0:1], 40
s_load_dwordx2 s[28:29], s[0:1], 56
s_load_dwordx2 s[32:33], s[0:1], 64
s_load_dwordx2 s[36:37], s[0:1], 72
s_load_dwordx2 s[40:41], s[0:1], 80
s_load_dwordx2 s[44:45], s[0:1], 88
s_mov_b32 s66, 0xffff0000
s_getpc_b64 s[86:87]
L_pc_here:
s_sub_u32 s86, s86, L_pc_here-sequential_preLN__ssm_conv_h3__mixer_token_mlp__prompt_kernel
s_subb_u32 s87, s87, 0
v_lshlrev_b32 v250, 7, v0
v_min_u32 v250, L_code_end-sequential_preLN__ssm_conv_h3__mixer_token_mlp__prompt_kernel-4, v250
global_load_dword v251, v250, s[86:87]
s_mul_i32 s60, s67, 10752
s_add_u32 s60, s60, 1048576
v_lshlrev_b32 v248, 4, v0
v_cmp_gt_u32 vcc, 224, v0
v_add_u32 v248, s60, v248
s_nop 0
v_cndmask_b32 v248, v4, v248, vcc
s_waitcnt vmcnt(1)
v_readfirstlane_b32 s53, v41
v_lshlrev_b32 v90, 16, v36
v_lshlrev_b32 v91, 16, v38
v_and_b32 v92, s66, v36
v_and_b32 v93, s66, v38
v_lshlrev_b32 v94, 16, v37
v_lshlrev_b32 v95, 16, v39
v_and_b32 v96, s66, v37
v_and_b32 v97, s66, v39
s_add_u32 s53, s53, 0x9e3779b9
v_lshlrev_b32 v68, 16, v8
v_and_b32 v69, s66, v8
v_lshlrev_b32 v70, 16, v9
v_and_b32 v71, s66, v9
v_lshlrev_b32 v72, 16, v10
v_and_b32 v73, s66, v10
v_lshlrev_b32 v74, 16, v11
v_and_b32 v75, s66, v11
v_lshlrev_b32 v76, 16, v12
v_and_b32 v77, s66, v12
v_lshlrev_b32 v78, 16, v13
v_and_b32 v79, s66, v13
v_lshlrev_b32 v80, 16, v14
v_and_b32 v81, s66, v14
v_lshlrev_b32 v82, 16, v15
v_and_b32 v83, s66, v15
v_lshlrev_b32 v84, 16, v16
v_and_b32 v85, s66, v16
v_lshlrev_b32 v86, 16, v17
v_and_b32 v87, s66, v17
v_lshlrev_b32 v88, 16, v18
v_and_b32 v89, s66, v18
v_pk_mul_f32 v[98:99], v[74:75], v[90:91]
v_pk_fma_f32 v[98:99], v[72:73], v[92:93], v[98:99]
v_pk_fma_f32 v[98:99], v[70:71], v[94:95], v[98:99]
v_pk_fma_f32 v[98:99], v[68:69], v[96:97], v[98:99]
v_lshlrev_b32 v124, 16, v20
v_and_b32 v125, s66, v20
v_pk_mul_f32 v[98:99], v[98:99], v[124:125]
v_pk_mul_f32 v[100:101], v[76:77], v[90:91]
v_pk_fma_f32 v[100:101], v[74:75], v[92:93], v[100:101]
v_pk_fma_f32 v[100:101], v[72:73], v[94:95], v[100:101]
v_pk_fma_f32 v[100:101], v[70:71], v[96:97], v[100:101]
v_lshlrev_b32 v124, 16, v21
v_and_b32 v125, s66, v21
v_pk_mul_f32 v[100:101], v[100:101], v[124:125]
v_pk_mul_f32 v[102:103], v[78:79], v[90:91]
v_pk_fma_f32 v[102:103], v[76:77], v[92:93], v[102:103]
v_pk_fma_f32 v[102:103], v[74:75], v[94:95], v[102:103]
v_pk_fma_f32 v[102:103], v[72:73], v[96:97], v[102:103]
v_lshlrev_b32 v124, 16, v22
v_and_b32 v125, s66, v22
v_pk_mul_f32 v[102:103], v[102:103], v[124:125]
v_pk_mul_f32 v[104:105], v[80:81], v[90:91]
v_pk_fma_f32 v[104:105], v[78:79], v[92:93], v[104:105]
v_pk_fma_f32 v[104:105], v[76:77], v[94:95], v[104:105]
v_pk_fma_f32 v[104:105], v[74:75], v[96:97], v[104:105]
v_lshlrev_b32 v124, 16, v23
v_and_b32 v125, s66, v23
v_pk_mul_f32 v[104:105], v[104:105], v[124:125]
v_pk_mul_f32 v[106:107], v[82:83], v[90:91]
v_pk_fma_f32 v[106:107], v[80:81], v[92:93], v[106:107]
v_pk_fma_f32 v[106:107], v[78:79], v[94:95], v[106:107]
v_pk_fma_f32 v[106:107], v[76:77], v[96:97], v[106:107]
v_lshlrev_b32 v124, 16, v24
v_and_b32 v125, s66, v24
v_pk_mul_f32 v[106:107], v[106:107], v[124:125]
v_pk_mul_f32 v[108:109], v[84:85], v[90:91]
v_pk_fma_f32 v[108:109], v[82:83], v[92:93], v[108:109]
v_pk_fma_f32 v[108:109], v[80:81], v[94:95], v[108:109]
v_pk_fma_f32 v[108:109], v[78:79], v[96:97], v[108:109]
v_lshlrev_b32 v124, 16, v25
v_and_b32 v125, s66, v25
v_pk_mul_f32 v[108:109], v[108:109], v[124:125]
v_pk_mul_f32 v[110:111], v[86:87], v[90:91]
v_pk_fma_f32 v[110:111], v[84:85], v[92:93], v[110:111]
v_pk_fma_f32 v[110:111], v[82:83], v[94:95], v[110:111]
v_pk_fma_f32 v[110:111], v[80:81], v[96:97], v[110:111]
v_lshlrev_b32 v124, 16, v26
v_and_b32 v125, s66, v26
v_pk_mul_f32 v[110:111], v[110:111], v[124:125]
v_pk_mul_f32 v[112:113], v[88:89], v[90:91]
v_pk_fma_f32 v[112:113], v[86:87], v[92:93], v[112:113]
v_pk_fma_f32 v[112:113], v[84:85], v[94:95], v[112:113]
v_pk_fma_f32 v[112:113], v[82:83], v[96:97], v[112:113]
v_lshlrev_b32 v124, 16, v27
v_and_b32 v125, s66, v27
v_pk_mul_f32 v[112:113], v[112:113], v[124:125]
v_cvt_pk_bf16_f32 v160, v112, v110
v_cvt_pk_bf16_f32 v161, v108, v106
v_cvt_pk_bf16_f32 v162, v104, v102
v_cvt_pk_bf16_f32 v168, v100, v98
v_cvt_pk_bf16_f32 v164, v113, v111
v_cvt_pk_bf16_f32 v165, v109, v107
v_cvt_pk_bf16_f32 v166, v105, v103
v_cvt_pk_bf16_f32 v169, v101, v99
v_mov_b32 v163, s53
v_mov_b32 v167, s53
v_mov_b32 v171, s53
v_mov_b32 v170, 0
s_mov_b32 s60, 7168
buffer_store_dwordx4 v[160:163], v248, s[48:51], 0 offen sc1
buffer_store_dwordx4 v[164:167], v248, s[48:51], 0 offen offset:3584 sc1
buffer_store_dwordx4 v[168:171], v248, s[48:51], s60 offen sc1
s_waitcnt lgkmcnt(0)
s_mov_b32 s6, 0x1c0000
s_mov_b32 s7, 0x20000
s_mov_b32 s22, 0x1c0000
s_mov_b32 s23, 0x20000
s_mov_b32 s26, 0x380
s_mov_b32 s27, 0x20000
s_mov_b32 s30, 0x700000
s_mov_b32 s31, 0x20000
s_mov_b32 s34, 0xe00
s_mov_b32 s35, 0x20000
s_mov_b32 s38, 0x700000
s_mov_b32 s39, 0x20000
s_mov_b32 s42, 0x1000
s_mov_b32 s43, 0x20000
s_mov_b32 s46, 0x1c0000
s_mov_b32 s47, 0x20000
v_lshrrev_b32 v114, 6, v0
v_and_b32 v1, 63, v0
v_readfirstlane_b32 s52, v114
s_mov_b32 s54, 0x40000
s_mul_i32 s57, s55, 28
s_add_u32 s57, s57, s56
s_mul_i32 s60, s56, 37
s_lshr_b32 s60, s60, 8
s_mul_i32 s61, s60, 7
s_sub_u32 s58, s56, s61
s_lshl_b32 s61, s55, 2
s_add_u32 s93, s61, s60
s_mul_i32 s62, s55, 3
s_add_u32 s62, s62, 4
s_cmp_lt_u32 s55, 4
s_cselect_b32 s61, s61, s62
s_cselect_b32 s63, 28, 21
s_cselect_b32 s62, 3, 2
s_min_u32 s62, s62, s60
s_add_u32 s59, s61, s62
s_cmp_lt_u32 s56, s63
s_cselect_b32 s94, 1, 0
s_lshl_b32 s96, s52, 15
s_mul_i32 s97, s52, 16384
s_add_u32 s97, s97, 51200
v_lshlrev_b32 v7, 4, v0
s_lshl_b32 s60, s57, 13
v_add_u32 v156, s60, v7
v_subrev_u32 v157, 64, v156
v_subrev_u32 v158, 48, v156
v_cmp_le_u32 vcc, 4, v0
s_mov_b32 s90, 4096
s_nop 0
v_cndmask_b32 v157, v4, v157, vcc
v_cmp_le_u32 vcc, 3, v0
s_nop 1
v_cndmask_b32 v158, v4, v158, vcc
v_cmp_le_u32 vcc, 4, v1
v_mov_b32 v7, 0
v_mov_b32 v159, 4032
v_cndmask_b32 v7, v7, v159, vcc
v_lshlrev_b32 v159, 4, v1
v_add3_u32 v7, v7, v159, s60
v_add_u32 v7, 4032, v7
v_cmp_gt_u32 vcc, 8, v1
s_nop 1
v_cndmask_b32 v159, v4, v7, vcc
v_mov_b32 v227, v3
v_mov_b32 v228, v5
v_mov_b32 v229, v2
s_cmp_ge_u32 s56, 28
s_cbranch_scc1 L_nossm_1
buffer_load_dwordx4 v[44:47], v157, s[20:23], 0 offen nt
buffer_load_dwordx2 v[48:49], v158, s[20:23], 0 offen nt
buffer_load_dwordx4 v[52:55], v157, s[20:23], s90 offen nt
buffer_load_dwordx2 v[56:57], v158, s[20:23], s90 offen nt
s_cmp_eq_u32 s52, 0
s_cbranch_scc0 L_noxl_2
buffer_load_dwordx4 v[60:63], v159, s[20:23], 0 offen nt
buffer_load_dwordx4 v[64:67], v159, s[20:23], 0 offen offset:16 nt
L_noxl_2:
s_branch L_qdone_3
L_nossm_1:
buffer_load_dword v232, v3, s[4:7], 0 offen offset:0 nt
buffer_load_dword v233, v3, s[4:7], 0 offen offset:896 nt
buffer_load_dword v234, v3, s[4:7], 0 offen offset:1792 nt
buffer_load_dword v235, v3, s[4:7], 0 offen offset:2688 nt
buffer_load_dword v236, v3, s[4:7], 0 offen offset:3584 nt
buffer_load_dword v237, v5, s[4:7], 0 offen offset:0 nt
buffer_load_dword v238, v5, s[4:7], 0 offen offset:896 nt
buffer_load_dword v239, v5, s[4:7], 0 offen offset:1792 nt
buffer_load_dword v42, v2, s[24:27], 0 offen
L_qdone_3:
v_lshrrev_b32 v114, 4, v1
v_bfe_u32 v115, v1, 2, 2
v_and_b32 v116, 3, v1
v_lshrrev_b32 v117, 1, v114
v_lshlrev_b32 v117, 10, v117
v_lshl_add_u32 v117, v115, 7, v117
v_and_b32 v114, 1, v114
v_lshl_add_u32 v117, v114, 5, v117
v_lshrrev_b32 v118, 1, v116
v_lshl_add_u32 v117, v118, 4, v117
v_and_b32 v118, 1, v116
v_lshl_add_u32 v117, v118, 3, v117
v_lshrrev_b32 v118, 1, v115
v_add_u32 v117, s97, v117
v_lshl_add_u32 v28, v118, 6, v117
v_xor_b32 v118, 1, v118
v_lshl_add_u32 v29, v118, 6, v117
s_lshl_b32 s61, s57, 4
s_add_u32 s61, s61, 1048576
v_mul_u32_u24 v243, 10752, v0
v_add_u32 v243, s61, v243
v_lshrrev_b32 v242, 2, v0
v_mul_u32_u24 v242, 96, v242
v_and_b32 v114, 3, v0
v_lshl_add_u32 v242, v114, 4, v242
v_add_u32 v242, 36864, v242
s_lshr_b32 s64, s52, 1
s_and_b32 s65, s52, 1
v_and_b32 v115, 15, v1
v_lshrrev_b32 v116, 4, v1
v_and_b32 v114, 3, v115
v_mul_u32_u24 v240, 4416, v114
v_lshrrev_b32 v114, 2, v115
v_lshl_add_u32 v240, v114, 3, v240
v_lshlrev_b32 v114, 4, v116
v_sub_u32 v240, v240, v114
s_mul_i32 s62, s64, 17664
s_lshl_b32 s63, s65, 6
s_add_u32 s62, s62, s63
s_add_u32 s62, s62, 48
v_add_u32 v240, s62, v240
v_mul_u32_u24 v241, 96, v115
v_lshl_add_u32 v241, v116, 4, v241
s_mul_i32 s62, s64, 7680
s_mul_i32 s63, s65, 96
s_sub_u32 s62, s62, s63
s_add_u32 s62, s62, 35520
v_add_u32 v241, s62, v241
s_sub_u32 s62, s55, 4
s_mul_i32 s62, s62, 7
s_add_u32 s62, s62, s56
s_sub_u32 s62, s62, 21
s_cmp_eq_u32 s94, 1
s_cselect_b32 s62, s59, s62
v_lshrrev_b32 v244, 3, v1
v_and_b32 v30, 7, v1
v_lshrrev_b32 v31, 2, v1
v_and_b32 v31, 4, v31
v_xor_b32 v30, v30, v31
v_mul_u32_u24 v244, 3584, v244
v_lshl_add_u32 v244, v30, 4, v244
s_mul_i32 s60, s52, 1835008
s_lshl_b32 s61, s62, 7
s_add_u32 s60, s60, s61
v_add_u32 v244, s60, v244
v_lshlrev_b32 v114, 4, v1
v_add_u32 v115, 118784, v114
v_mov_b32 v226, v115
s_lshl_b32 s62, s52, 11
v_add_u32 v245, s62, v115
s_lshl_b32 s62, s52, 13
v_add_u32 v246, s62, v115
s_mul_i32 s62, s57, 12288
s_lshl_b32 s63, s52, 10
s_add_u32 s62, s62, s63
s_add_u32 s62, s62, 4194304
v_add_u32 v247, s62, v114
v_lshrrev_b32 v114, 4, v1
v_lshrrev_b32 v115, 1, v114
v_and_b32 v114, 1, v114
v_lshlrev_b32 v115, 7, v115
v_lshl_add_u32 v224, v114, 6, v115
s_lshl_b32 s60, s52, 2
s_add_u32 s60, s60, 163328
v_add_u32 v224, s60, v224
v_and_b32 v225, 7, v1
v_lshlrev_b32 v225, 4, v225
v_add_u32 v225, 163328, v225
s_cmp_ge_u32 s56, 28
s_cbranch_scc1 L_noconv_4
s_cmp_eq_u32 s94, 1
s_cselect_b32 s8, s28, s36
s_cselect_b32 s9, s29, s37
s_mov_b32 s10, 0x700000
s_mov_b32 s11, 0x20000
v_mov_b32 v26, v244
s_mov_b32 s90, 7168
s_waitcnt vmcnt(0)
buffer_load_dwordx4 v[68:71], v243, s[48:51], 0 offen offset:0 sc1
buffer_load_dwordx4 v[72:75], v243, s[48:51], 0 offen offset:3584 sc1
buffer_load_dwordx4 v[76:79], v243, s[48:51], s90 offen offset:0 sc1
v_lshlrev_b32 v2, 4, v0
v_alignbit_b32 v128, v45, v44, 16
v_alignbit_b32 v129, v46, v45, 16
v_alignbit_b32 v130, v47, v46, 16
v_alignbit_b32 v131, v48, v47, 16
v_alignbit_b32 v132, v46, v45, 16
v_alignbit_b32 v133, v47, v46, 16
v_alignbit_b32 v134, v48, v47, 16
v_alignbit_b32 v135, v49, v48, 16
v_mov_b32 v136, v45
v_mov_b32 v137, v46
v_mov_b32 v138, v47
v_mov_b32 v139, v48
ds_write_b128 v2, v[46:49] offset:13248
ds_write_b128 v2, v[128:131] offset:0
ds_write_b128 v2, v[132:135] offset:8832
ds_write_b128 v2, v[136:139] offset:4416
v_alignbit_b32 v128, v53, v52, 16
v_alignbit_b32 v129, v54, v53, 16
v_alignbit_b32 v130, v55, v54, 16
v_alignbit_b32 v131, v56, v55, 16
v_alignbit_b32 v132, v54, v53, 16
v_alignbit_b32 v133, v55, v54, 16
v_alignbit_b32 v134, v56, v55, 16
v_alignbit_b32 v135, v57, v56, 16
v_mov_b32 v136, v53
v_mov_b32 v137, v54
v_mov_b32 v138, v55
v_mov_b32 v139, v56
ds_write_b128 v2, v[54:57] offset:30912
ds_write_b128 v2, v[128:131] offset:17664
ds_write_b128 v2, v[132:135] offset:26496
ds_write_b128 v2, v[136:139] offset:22080
s_cmp_eq_u32 s52, 0
s_cbranch_scc0 L_noextra_9
v_cmp_le_u32 vcc, 4, v1
v_mov_b32 v2, 0
v_mov_b32 v3, 17600
v_cndmask_b32 v2, v2, v3, vcc
v_lshlrev_b32 v3, 4, v1
v_add_u32 v2, v2, v3
v_add_u32 v2, 4096, v2
s_mov_b64 s[84:85], exec
s_mov_b64 exec, 0xff
v_alignbit_b32 v128, v61, v60, 16
v_alignbit_b32 v129, v62, v61, 16
v_alignbit_b32 v130, v63, v62, 16
v_alignbit_b32 v131, v64, v63, 16
v_alignbit_b32 v132, v62, v61, 16
v_alignbit_b32 v133, v63, v62, 16
v_alignbit_b32 v134, v64, v63, 16
v_alignbit_b32 v135, v65, v64, 16
v_mov_b32 v136, v61
v_mov_b32 v137, v62
v_mov_b32 v138, v63
v_mov_b32 v139, v64
ds_write_b128 v2, v[62:65] offset:13248
ds_write_b128 v2, v[128:131] offset:0
ds_write_b128 v2, v[132:135] offset:8832
ds_write_b128 v2, v[136:139] offset:4416
s_mov_b64 exec, s[84:85]
L_noextra_9:
v_mov_b32 v128, 0
v_mov_b32 v129, 0
v_mov_b32 v130, 0
v_mov_b32 v131, 0
v_lshlrev_b32 v2, 4, v0
v_add_u32 v2, 35328, v2
v_cmp_gt_u32 vcc, 96, v0
s_and_saveexec_b64 s[84:85], vcc
s_cbranch_execz L_noz_10
ds_write_b128 v2, v[128:131]
ds_write_b128 v2, v[128:131] offset:7680
L_noz_10:
s_mov_b64 exec, s[84:85]
s_branch L_gathchk_8
L_gath_6:
buffer_load_dwordx4 v[68:71], v243, s[48:51], 0 offen offset:0 sc1
buffer_load_dwordx4 v[72:75], v243, s[48:51], 0 offen offset:3584 sc1
buffer_load_dwordx4 v[76:79], v243, s[48:51], s90 offen offset:0 sc1
L_gathchk_8:
s_waitcnt vmcnt(0)
v_xor_b32 v71, s53, v71
v_xor_b32 v75, s53, v75
v_xor_b32 v79, s53, v79
v_or3_b32 v71, v71, v75, v79
v_cmp_ne_u32 vcc, 0, v71
s_nop 1
s_cbranch_vccz L_gathok_7
s_mov_b64 exec, vcc
s_sub_u32 s54, s54, 1
s_cmp_gt_i32 s54, 0
s_cbranch_scc1 L_gath_6
L_gathok_7:
s_mov_b64 exec, -1
v_mov_b32 v71, v76
v_mov_b32 v75, v77
ds_write_b128 v242, v[68:71]
ds_write_b128 v242, v[72:75] offset:7680
s_waitcnt lgkmcnt(0)
s_barrier
ds_read_b128 v[128:131], v241 offset:1344
ds_read_b128 v[132:135], v241 offset:2880
ds_read_b128 v[136:139], v241 offset:4416
ds_read_b128 v[140:143], v241 offset:5952
ds_read_b64 v[96:97], v240 offset:0
ds_read_b64 v[98:99], v240 offset:8
ds_read_b64 v[100:101], v240 offset:32
ds_read_b64 v[102:103], v240 offset:40
ds_read_b64 v[104:105], v240 offset:1024
ds_read_b64 v[106:107], v240 offset:1032
ds_read_b64 v[108:109], v240 offset:1056
ds_read_b64 v[110:111], v240 offset:1064
ds_read_b64 v[112:113], v240 offset:2048
ds_read_b64 v[114:115], v240 offset:2056
ds_read_b64 v[116:117], v240 offset:2080
ds_read_b64 v[118:119], v240 offset:2088
s_waitcnt lgkmcnt(8)
v_mfma_f32_16x16x32_bf16 v[64:67], v[96:99], v[128:131], 0
ds_read_b64 v[120:121], v240 offset:3072
s_add_u32 s95, s97, 0
v_mfma_f32_16x16x32_bf16 v[68:71], v[100:103], v[128:131], 0
ds_read_b64 v[122:123], v240 offset:3080
s_mov_b32 m0, s95
v_mfma_f32_16x16x32_bf16 v[72:75], v[96:99], v[132:135], 0
ds_read_b64 v[124:125], v240 offset:3104
s_mov_b32 s92, 0
v_mfma_f32_16x16x32_bf16 v[76:79], v[100:103], v[132:135], 0
ds_read_b64 v[126:127], v240 offset:3112
buffer_load_dwordx4 v26, s[8:11], s92 offen offset:0 lds
v_mfma_f32_16x16x32_bf16 v[80:83], v[96:99], v[136:139], 0
ds_read_b128 v[144:147], v241 offset:1152
v_mfma_f32_16x16x32_bf16 v[84:87], v[100:103], v[136:139], 0
ds_read_b128 v[148:151], v241 offset:2688
v_mfma_f32_16x16x32_bf16 v[88:91], v[96:99], v[140:143], 0
v_mfma_f32_16x16x32_bf16 v[92:95], v[100:103], v[140:143], 0
s_waitcnt lgkmcnt(10)
v_mfma_f32_16x16x32_bf16 v[72:75], v[104:107], v[128:131], v[72:75]
ds_read_b64 v[96:97], v240 offset:128
buffer_load_dword v232, v227, s[4:7], 0 offen offset:0 nt
v_mfma_f32_16x16x32_bf16 v[76:79], v[108:111], v[128:131], v[76:79]
ds_read_b64 v[98:99], v240 offset:136
v_mfma_f32_16x16x32_bf16 v[80:83], v[104:107], v[132:135], v[80:83]
ds_read_b64 v[100:101], v240 offset:160
v_mfma_f32_16x16x32_bf16 v[84:87], v[108:111], v[132:135], v[84:87]
ds_read_b64 v[102:103], v240 offset:168
v_mfma_f32_16x16x32_bf16 v[88:91], v[104:107], v[136:139], v[88:91]
ds_read_b128 v[152:155], v241 offset:4224
v_mfma_f32_16x16x32_bf16 v[92:95], v[108:111], v[136:139], v[92:95]
ds_read_b128 v[156:159], v241 offset:5760
s_waitcnt lgkmcnt(12)
v_mfma_f32_16x16x32_bf16 v[80:83], v[112:115], v[128:131], v[80:83]
ds_read_b64 v[104:105], v240 offset:1152
s_mov_b32 s92, 27648
v_mfma_f32_16x16x32_bf16 v[84:87], v[116:119], v[128:131], v[84:87]
ds_read_b64 v[106:107], v240 offset:1160
buffer_load_dwordx4 v26, s[8:11], s92 offen offset:1024 lds
v_mfma_f32_16x16x32_bf16 v[88:91], v[112:115], v[132:135], v[88:91]
ds_read_b64 v[108:109], v240 offset:1184
buffer_load_dword v233, v227, s[4:7], 0 offen offset:896 nt
v_mfma_f32_16x16x32_bf16 v[92:95], v[116:119], v[132:135], v[92:95]
ds_read_b64 v[110:111], v240 offset:1192
s_waitcnt lgkmcnt(12)
v_mfma_f32_16x16x32_bf16 v[88:91], v[120:123], v[128:131], v[88:91]
ds_read_b64 v[112:113], v240 offset:2176
s_mov_b32 s92, 55296
v_mfma_f32_16x16x32_bf16 v[92:95], v[124:127], v[128:131], v[92:95]
ds_read_b64 v[114:115], v240 offset:2184
buffer_load_dwordx4 v26, s[8:11], s92 offen offset:2048 lds
s_waitcnt lgkmcnt(6)
v_mfma_f32_16x16x32_bf16 v[64:67], v[96:99], v[144:147], v[64:67]
ds_read_b64 v[116:117], v240 offset:2208
buffer_load_dword v234, v227, s[4:7], 0 offen offset:1792 nt
v_mfma_f32_16x16x32_bf16 v[68:71], v[100:103], v[144:147], v[68:71]
ds_read_b64 v[118:119], v240 offset:2216
buffer_load_dword v235, v227, s[4:7], 0 offen offset:2688 nt
v_mfma_f32_16x16x32_bf16 v[72:75], v[96:99], v[148:151], v[72:75]
ds_read_b64 v[120:121], v240 offset:3200
v_mfma_f32_16x16x32_bf16 v[76:79], v[100:103], v[148:151], v[76:79]
ds_read_b64 v[122:123], v240 offset:3208
v_mfma_f32_16x16x32_bf16 v[80:83], v[96:99], v[152:155], v[80:83]
ds_read_b64 v[124:125], v240 offset:3232
v_mfma_f32_16x16x32_bf16 v[84:87], v[100:103], v[152:155], v[84:87]
ds_read_b64 v[126:127], v240 offset:3240
v_mfma_f32_16x16x32_bf16 v[88:91], v[96:99], v[156:159], v[88:91]
ds_read_b128 v[128:131], v241 offset:960
v_mfma_f32_16x16x32_bf16 v[92:95], v[100:103], v[156:159], v[92:95]
ds_read_b128 v[132:135], v241 offset:2496
s_waitcnt lgkmcnt(10)
v_mfma_f32_16x16x32_bf16 v[72:75], v[104:107], v[144:147], v[72:75]
ds_read_b64 v[96:97], v240 offset:256
s_mov_b32 s92, 82944
v_mfma_f32_16x16x32_bf16 v[76:79], v[108:111], v[144:147], v[76:79]
ds_read_b64 v[98:99], v240 offset:264
buffer_load_dwordx4 v26, s[8:11], s92 offen offset:3072 lds
v_mfma_f32_16x16x32_bf16 v[80:83], v[104:107], v[148:151], v[80:83]
ds_read_b64 v[100:101], v240 offset:288
buffer_load_dword v236, v227, s[4:7], 0 offen offset:3584 nt
v_mfma_f32_16x16x32_bf16 v[84:87], v[108:111], v[148:151], v[84:87]
ds_read_b64 v[102:103], v240 offset:296
v_mfma_f32_16x16x32_bf16 v[88:91], v[104:107], v[152:155], v[88:91]
ds_read_b128 v[136:139], v241 offset:4032
v_mfma_f32_16x16x32_bf16 v[92:95], v[108:111], v[152:155], v[92:95]
ds_read_b128 v[140:143], v241 offset:5568
s_waitcnt lgkmcnt(12)
v_mfma_f32_16x16x32_bf16 v[80:83], v[112:115], v[144:147], v[80:83]
ds_read_b64 v[104:105], v240 offset:1280
s_add_u32 s95, s97, 4096
v_mfma_f32_16x16x32_bf16 v[84:87], v[116:119], v[144:147], v[84:87]
ds_read_b64 v[106:107], v240 offset:1288
s_mov_b32 m0, s95
v_mfma_f32_16x16x32_bf16 v[88:91], v[112:115], v[148:151], v[88:91]
ds_read_b64 v[108:109], v240 offset:1312
s_mov_b32 s92, 114688
v_mfma_f32_16x16x32_bf16 v[92:95], v[116:119], v[148:151], v[92:95]
ds_read_b64 v[110:111], v240 offset:1320
buffer_load_dwordx4 v26, s[8:11], s92 offen offset:0 lds
s_waitcnt lgkmcnt(12)
v_mfma_f32_16x16x32_bf16 v[88:91], v[120:123], v[144:147], v[88:91]
ds_read_b64 v[112:113], v240 offset:2304
buffer_load_dword v237, v228, s[4:7], 0 offen offset:0 nt
v_mfma_f32_16x16x32_bf16 v[92:95], v[124:127], v[144:147], v[92:95]
ds_read_b64 v[114:115], v240 offset:2312
buffer_load_dword v238, v228, s[4:7], 0 offen offset:896 nt
s_waitcnt lgkmcnt(6)
v_mfma_f32_16x16x32_bf16 v[64:67], v[96:99], v[128:131], v[64:67]
ds_read_b64 v[116:117], v240 offset:2336
s_mov_b32 s92, 142336
v_mfma_f32_16x16x32_bf16 v[68:71], v[100:103], v[128:131], v[68:71]
ds_read_b64 v[118:119], v240 offset:2344
buffer_load_dwordx4 v26, s[8:11], s92 offen offset:1024 lds
v_mfma_f32_16x16x32_bf16 v[72:75], v[96:99], v[132:135], v[72:75]
ds_read_b64 v[120:121], v240 offset:3328
buffer_load_dword v239, v228, s[4:7], 0 offen offset:1792 nt
v_mfma_f32_16x16x32_bf16 v[76:79], v[100:103], v[132:135], v[76:79]
ds_read_b64 v[122:123], v240 offset:3336
v_mfma_f32_16x16x32_bf16 v[80:83], v[96:99], v[136:139], v[80:83]
ds_read_b64 v[124:125], v240 offset:3360
v_mfma_f32_16x16x32_bf16 v[84:87], v[100:103], v[136:139], v[84:87]
ds_read_b64 v[126:127], v240 offset:3368
v_mfma_f32_16x16x32_bf16 v[88:91], v[96:99], v[140:143], v[88:91]
ds_read_b128 v[144:147], v241 offset:768
v_mfma_f32_16x16x32_bf16 v[92:95], v[100:103], v[140:143], v[92:95]
ds_read_b128 v[148:151], v241 offset:2304
s_waitcnt lgkmcnt(10)
v_mfma_f32_16x16x32_bf16 v[72:75], v[104:107], v[128:131], v[72:75]
ds_read_b64 v[96:97], v240 offset:384
s_mov_b32 s92, 169984
v_mfma_f32_16x16x32_bf16 v[76:79], v[108:111], v[128:131], v[76:79]
ds_read_b64 v[98:99], v240 offset:392
buffer_load_dwordx4 v26, s[8:11], s92 offen offset:2048 lds
v_mfma_f32_16x16x32_bf16 v[80:83], v[104:107], v[132:135], v[80:83]
ds_read_b64 v[100:101], v240 offset:416
buffer_load_dword v42, v229, s[24:27], 0 offen
v_mfma_f32_16x16x32_bf16 v[84:87], v[108:111], v[132:135], v[84:87]
ds_read_b64 v[102:103], v240 offset:424
v_mfma_f32_16x16x32_bf16 v[88:91], v[104:107], v[136:139], v[88:91]
ds_read_b128 v[152:155], v241 offset:3840
v_mfma_f32_16x16x32_bf16 v[92:95], v[108:111], v[136:139], v[92:95]
ds_read_b128 v[156:159], v241 offset:5376
s_waitcnt lgkmcnt(12)
v_mfma_f32_16x16x32_bf16 v[80:83], v[112:115], v[128:131], v[80:83]
ds_read_b64 v[104:105], v240 offset:1408
v_mfma_f32_16x16x32_bf16 v[84:87], v[116:119], v[128:131], v[84:87]
ds_read_b64 v[106:107], v240 offset:1416
v_mfma_f32_16x16x32_bf16 v[88:91], v[112:115], v[132:135], v[88:91]
ds_read_b64 v[108:109], v240 offset:1440
v_mfma_f32_16x16x32_bf16 v[92:95], v[116:119], v[132:135], v[92:95]
ds_read_b64 v[110:111], v240 offset:1448
s_waitcnt lgkmcnt(12)
v_mfma_f32_16x16x32_bf16 v[88:91], v[120:123], v[128:131], v[88:91]
ds_read_b64 v[112:113], v240 offset:2432
s_mov_b32 s92, 197632
v_mfma_f32_16x16x32_bf16 v[92:95], v[124:127], v[128:131], v[92:95]
ds_read_b64 v[114:115], v240 offset:2440
buffer_load_dwordx4 v26, s[8:11], s92 offen offset:3072 lds
s_waitcnt lgkmcnt(6)
v_mfma_f32_16x16x32_bf16 v[64:67], v[96:99], v[144:147], v[64:67]
ds_read_b64 v[116:117], v240 offset:2464
s_add_u32 s95, s97, 8192
v_mfma_f32_16x16x32_bf16 v[68:71], v[100:103], v[144:147], v[68:71]
ds_read_b64 v[118:119], v240 offset:2472
s_mov_b32 m0, s95
v_mfma_f32_16x16x32_bf16 v[72:75], v[96:99], v[148:151], v[72:75]
ds_read_b64 v[120:121], v240 offset:3456
s_mov_b32 s92, 229376
v_mfma_f32_16x16x32_bf16 v[76:79], v[100:103], v[148:151], v[76:79]
ds_read_b64 v[122:123], v240 offset:3464
buffer_load_dwordx4 v26, s[8:11], s92 offen offset:0 lds
v_mfma_f32_16x16x32_bf16 v[80:83], v[96:99], v[152:155], v[80:83]
ds_read_b64 v[124:125], v240 offset:3488
v_mfma_f32_16x16x32_bf16 v[84:87], v[100:103], v[152:155], v[84:87]
ds_read_b64 v[126:127], v240 offset:3496
v_mfma_f32_16x16x32_bf16 v[88:91], v[96:99], v[156:159], v[88:91]
ds_read_b128 v[128:131], v241 offset:576
v_mfma_f32_16x16x32_bf16 v[92:95], v[100:103], v[156:159], v[92:95]
ds_read_b128 v[132:135], v241 offset:2112
s_waitcnt lgkmcnt(10)
v_mfma_f32_16x16x32_bf16 v[72:75], v[104:107], v[144:147], v[72:75]
ds_read_b64 v[96:97], v240 offset:512
v_mfma_f32_16x16x32_bf16 v[76:79], v[108:111], v[144:147], v[76:79]
ds_read_b64 v[98:99], v240 offset:520
v_mfma_f32_16x16x32_bf16 v[80:83], v[104:107], v[148:151], v[80:83]
ds_read_b64 v[100:101], v240 offset:544
v_mfma_f32_16x16x32_bf16 v[84:87], v[108:111], v[148:151], v[84:87]
ds_read_b64 v[102:103], v240 offset:552
v_mfma_f32_16x16x32_bf16 v[88:91], v[104:107], v[152:155], v[88:91]
ds_read_b128 v[136:139], v241 offset:3648
v_mfma_f32_16x16x32_bf16 v[92:95], v[108:111], v[152:155], v[92:95]
ds_read_b128 v[140:143], v241 offset:5184
s_waitcnt lgkmcnt(12)
v_mfma_f32_16x16x32_bf16 v[80:83], v[112:115], v[144:147], v[80:83]
ds_read_b64 v[104:105], v240 offset:1536
s_mov_b32 s92, 257024
v_mfma_f32_16x16x32_bf16 v[84:87], v[116:119], v[144:147], v[84:87]
ds_read_b64 v[106:107], v240 offset:1544
buffer_load_dwordx4 v26, s[8:11], s92 offen offset:1024 lds
v_mfma_f32_16x16x32_bf16 v[88:91], v[112:115], v[148:151], v[88:91]
ds_read_b64 v[108:109], v240 offset:1568
v_mfma_f32_16x16x32_bf16 v[92:95], v[116:119], v[148:151], v[92:95]
ds_read_b64 v[110:111], v240 offset:1576
s_waitcnt lgkmcnt(12)
v_mfma_f32_16x16x32_bf16 v[88:91], v[120:123], v[144:147], v[88:91]
ds_read_b64 v[112:113], v240 offset:2560
s_mov_b32 s92, 284672
v_mfma_f32_16x16x32_bf16 v[92:95], v[124:127], v[144:147], v[92:95]
ds_read_b64 v[114:115], v240 offset:2568
buffer_load_dwordx4 v26, s[8:11], s92 offen offset:2048 lds
s_waitcnt lgkmcnt(6)
v_mfma_f32_16x16x32_bf16 v[64:67], v[96:99], v[128:131], v[64:67]
ds_read_b64 v[116:117], v240 offset:2592
v_mfma_f32_16x16x32_bf16 v[68:71], v[100:103], v[128:131], v[68:71]
ds_read_b64 v[118:119], v240 offset:2600
v_mfma_f32_16x16x32_bf16 v[72:75], v[96:99], v[132:135], v[72:75]
ds_read_b64 v[120:121], v240 offset:3584
v_mfma_f32_16x16x32_bf16 v[76:79], v[100:103], v[132:135], v[76:79]
ds_read_b64 v[122:123], v240 offset:3592
v_mfma_f32_16x16x32_bf16 v[80:83], v[96:99], v[136:139], v[80:83]
ds_read_b64 v[124:125], v240 offset:3616
v_mfma_f32_16x16x32_bf16 v[84:87], v[100:103], v[136:139], v[84:87]
ds_read_b64 v[126:127], v240 offset:3624
v_mfma_f32_16x16x32_bf16 v[88:91], v[96:99], v[140:143], v[88:91]
ds_read_b128 v[144:147], v241 offset:384
v_mfma_f32_16x16x32_bf16 v[92:95], v[100:103], v[140:143], v[92:95]
ds_read_b128 v[148:151], v241 offset:1920
s_waitcnt lgkmcnt(10)
v_mfma_f32_16x16x32_bf16 v[72:75], v[104:107], v[128:131], v[72:75]
ds_read_b64 v[96:97], v240 offset:640
s_mov_b32 s92, 312320
v_mfma_f32_16x16x32_bf16 v[76:79], v[108:111], v[128:131], v[76:79]
ds_read_b64 v[98:99], v240 offset:648
buffer_load_dwordx4 v26, s[8:11], s92 offen offset:3072 lds
v_mfma_f32_16x16x32_bf16 v[80:83], v[104:107], v[132:135], v[80:83]
ds_read_b64 v[100:101], v240 offset:672
v_mfma_f32_16x16x32_bf16 v[84:87], v[108:111], v[132:135], v[84:87]
ds_read_b64 v[102:103], v240 offset:680
v_mfma_f32_16x16x32_bf16 v[88:91], v[104:107], v[136:139], v[88:91]
ds_read_b128 v[152:155], v241 offset:3456
v_mfma_f32_16x16x32_bf16 v[92:95], v[108:111], v[136:139], v[92:95]
ds_read_b128 v[156:159], v241 offset:4992
s_waitcnt lgkmcnt(12)
v_mfma_f32_16x16x32_bf16 v[80:83], v[112:115], v[128:131], v[80:83]
ds_read_b64 v[104:105], v240 offset:1664
s_add_u32 s95, s97, 12288
v_mfma_f32_16x16x32_bf16 v[84:87], v[116:119], v[128:131], v[84:87]
ds_read_b64 v[106:107], v240 offset:1672
s_mov_b32 m0, s95
v_mfma_f32_16x16x32_bf16 v[88:91], v[112:115], v[132:135], v[88:91]
ds_read_b64 v[108:109], v240 offset:1696
s_mov_b32 s92, 344064
v_mfma_f32_16x16x32_bf16 v[92:95], v[116:119], v[132:135], v[92:95]
ds_read_b64 v[110:111], v240 offset:1704
buffer_load_dwordx4 v26, s[8:11], s92 offen offset:0 lds
s_waitcnt lgkmcnt(12)
v_mfma_f32_16x16x32_bf16 v[88:91], v[120:123], v[128:131], v[88:91]
ds_read_b64 v[112:113], v240 offset:2688
v_mfma_f32_16x16x32_bf16 v[92:95], v[124:127], v[128:131], v[92:95]
ds_read_b64 v[114:115], v240 offset:2696
s_waitcnt lgkmcnt(6)
v_mfma_f32_16x16x32_bf16 v[64:67], v[96:99], v[144:147], v[64:67]
ds_read_b64 v[116:117], v240 offset:2720
s_mov_b32 s92, 371712
v_mfma_f32_16x16x32_bf16 v[68:71], v[100:103], v[144:147], v[68:71]
ds_read_b64 v[118:119], v240 offset:2728
buffer_load_dwordx4 v26, s[8:11], s92 offen offset:1024 lds
v_mfma_f32_16x16x32_bf16 v[72:75], v[96:99], v[148:151], v[72:75]
ds_read_b64 v[120:121], v240 offset:3712
v_mfma_f32_16x16x32_bf16 v[76:79], v[100:103], v[148:151], v[76:79]
ds_read_b64 v[122:123], v240 offset:3720
v_mfma_f32_16x16x32_bf16 v[80:83], v[96:99], v[152:155], v[80:83]
ds_read_b64 v[124:125], v240 offset:3744
v_mfma_f32_16x16x32_bf16 v[84:87], v[100:103], v[152:155], v[84:87]
ds_read_b64 v[126:127], v240 offset:3752
v_mfma_f32_16x16x32_bf16 v[88:91], v[96:99], v[156:159], v[88:91]
ds_read_b128 v[128:131], v241 offset:192
v_mfma_f32_16x16x32_bf16 v[92:95], v[100:103], v[156:159], v[92:95]
ds_read_b128 v[132:135], v241 offset:1728
s_waitcnt lgkmcnt(10)
v_mfma_f32_16x16x32_bf16 v[72:75], v[104:107], v[144:147], v[72:75]
ds_read_b64 v[96:97], v240 offset:768
s_mov_b32 s92, 399360
v_mfma_f32_16x16x32_bf16 v[76:79], v[108:111], v[144:147], v[76:79]
ds_read_b64 v[98:99], v240 offset:776
buffer_load_dwordx4 v26, s[8:11], s92 offen offset:2048 lds
v_mfma_f32_16x16x32_bf16 v[80:83], v[104:107], v[148:151], v[80:83]
ds_read_b64 v[100:101], v240 offset:800
v_mfma_f32_16x16x32_bf16 v[84:87], v[108:111], v[148:151], v[84:87]
ds_read_b64 v[102:103], v240 offset:808
v_mfma_f32_16x16x32_bf16 v[88:91], v[104:107], v[152:155], v[88:91]
ds_read_b128 v[136:139], v241 offset:3264
v_mfma_f32_16x16x32_bf16 v[92:95], v[108:111], v[152:155], v[92:95]
ds_read_b128 v[140:143], v241 offset:4800
s_waitcnt lgkmcnt(12)
v_mfma_f32_16x16x32_bf16 v[80:83], v[112:115], v[144:147], v[80:83]
ds_read_b64 v[104:105], v240 offset:1792
v_mfma_f32_16x16x32_bf16 v[84:87], v[116:119], v[144:147], v[84:87]
ds_read_b64 v[106:107], v240 offset:1800
v_mfma_f32_16x16x32_bf16 v[88:91], v[112:115], v[148:151], v[88:91]
ds_read_b64 v[108:109], v240 offset:1824
v_mfma_f32_16x16x32_bf16 v[92:95], v[116:119], v[148:151], v[92:95]
ds_read_b64 v[110:111], v240 offset:1832
s_waitcnt lgkmcnt(12)
v_mfma_f32_16x16x32_bf16 v[88:91], v[120:123], v[144:147], v[88:91]
ds_read_b64 v[112:113], v240 offset:2816
s_mov_b32 s92, 427008
v_mfma_f32_16x16x32_bf16 v[92:95], v[124:127], v[144:147], v[92:95]
ds_read_b64 v[114:115], v240 offset:2824
buffer_load_dwordx4 v26, s[8:11], s92 offen offset:3072 lds
s_waitcnt lgkmcnt(6)
v_mfma_f32_16x16x32_bf16 v[64:67], v[96:99], v[128:131], v[64:67]
ds_read_b64 v[116:117], v240 offset:2848
v_mfma_f32_16x16x32_bf16 v[68:71], v[100:103], v[128:131], v[68:71]
ds_read_b64 v[118:119], v240 offset:2856
v_mfma_f32_16x16x32_bf16 v[72:75], v[96:99], v[132:135], v[72:75]
ds_read_b64 v[120:121], v240 offset:3840
v_mfma_f32_16x16x32_bf16 v[76:79], v[100:103], v[132:135], v[76:79]
ds_read_b64 v[122:123], v240 offset:3848
v_mfma_f32_16x16x32_bf16 v[80:83], v[96:99], v[136:139], v[80:83]
ds_read_b64 v[124:125], v240 offset:3872
v_mfma_f32_16x16x32_bf16 v[84:87], v[100:103], v[136:139], v[84:87]
ds_read_b64 v[126:127], v240 offset:3880
v_mfma_f32_16x16x32_bf16 v[88:91], v[96:99], v[140:143], v[88:91]
ds_read_b128 v[144:147], v241 offset:0
v_mfma_f32_16x16x32_bf16 v[92:95], v[100:103], v[140:143], v[92:95]
ds_read_b128 v[148:151], v241 offset:1536
s_waitcnt lgkmcnt(10)
v_mfma_f32_16x16x32_bf16 v[72:75], v[104:107], v[128:131], v[72:75]
ds_read_b64 v[96:97], v240 offset:896
v_mfma_f32_16x16x32_bf16 v[76:79], v[108:111], v[128:131], v[76:79]
ds_read_b64 v[98:99], v240 offset:904
v_mfma_f32_16x16x32_bf16 v[80:83], v[104:107], v[132:135], v[80:83]
ds_read_b64 v[100:101], v240 offset:928
v_mfma_f32_16x16x32_bf16 v[84:87], v[108:111], v[132:135], v[84:87]
ds_read_b64 v[102:103], v240 offset:936
v_mfma_f32_16x16x32_bf16 v[88:91], v[104:107], v[136:139], v[88:91]
ds_read_b128 v[152:155], v241 offset:3072
v_mfma_f32_16x16x32_bf16 v[92:95], v[108:111], v[136:139], v[92:95]
ds_read_b128 v[156:159], v241 offset:4608
s_waitcnt lgkmcnt(12)
v_mfma_f32_16x16x32_bf16 v[80:83], v[112:115], v[128:131], v[80:83]
ds_read_b64 v[104:105], v240 offset:1920
v_mfma_f32_16x16x32_bf16 v[84:87], v[116:119], v[128:131], v[84:87]
ds_read_b64 v[106:107], v240 offset:1928
v_mfma_f32_16x16x32_bf16 v[88:91], v[112:115], v[132:135], v[88:91]
ds_read_b64 v[108:109], v240 offset:1952
v_mfma_f32_16x16x32_bf16 v[92:95], v[116:119], v[132:135], v[92:95]
ds_read_b64 v[110:111], v240 offset:1960
s_waitcnt lgkmcnt(12)
v_mfma_f32_16x16x32_bf16 v[88:91], v[120:123], v[128:131], v[88:91]
ds_read_b64 v[112:113], v240 offset:2944
v_mfma_f32_16x16x32_bf16 v[92:95], v[124:127], v[128:131], v[92:95]
ds_read_b64 v[114:115], v240 offset:2952
s_waitcnt lgkmcnt(6)
v_mfma_f32_16x16x32_bf16 v[64:67], v[96:99], v[144:147], v[64:67]
ds_read_b64 v[116:117], v240 offset:2976
v_mfma_f32_16x16x32_bf16 v[68:71], v[100:103], v[144:147], v[68:71]
ds_read_b64 v[118:119], v240 offset:2984
v_mfma_f32_16x16x32_bf16 v[72:75], v[96:99], v[148:151], v[72:75]
ds_read_b64 v[120:121], v240 offset:3968
v_mfma_f32_16x16x32_bf16 v[76:79], v[100:103], v[148:151], v[76:79]
ds_read_b64 v[122:123], v240 offset:3976
v_mfma_f32_16x16x32_bf16 v[80:83], v[96:99], v[152:155], v[80:83]
ds_read_b64 v[124:125], v240 offset:4000
v_mfma_f32_16x16x32_bf16 v[84:87], v[100:103], v[152:155], v[84:87]
ds_read_b64 v[126:127], v240 offset:4008
v_mfma_f32_16x16x32_bf16 v[88:91], v[96:99], v[156:159], v[88:91]
v_mfma_f32_16x16x32_bf16 v[92:95], v[100:103], v[156:159], v[92:95]
s_waitcnt lgkmcnt(8)
v_mfma_f32_16x16x32_bf16 v[72:75], v[104:107], v[144:147], v[72:75]
v_mfma_f32_16x16x32_bf16 v[76:79], v[108:111], v[144:147], v[76:79]
v_mfma_f32_16x16x32_bf16 v[80:83], v[104:107], v[148:151], v[80:83]
v_mfma_f32_16x16x32_bf16 v[84:87], v[108:111], v[148:151], v[84:87]
v_mfma_f32_16x16x32_bf16 v[88:91], v[104:107], v[152:155], v[88:91]
v_mfma_f32_16x16x32_bf16 v[92:95], v[108:111], v[152:155], v[92:95]
s_waitcnt lgkmcnt(4)
v_mfma_f32_16x16x32_bf16 v[80:83], v[112:115], v[144:147], v[80:83]
v_mfma_f32_16x16x32_bf16 v[84:87], v[116:119], v[144:147], v[84:87]
v_mfma_f32_16x16x32_bf16 v[88:91], v[112:115], v[148:151], v[88:91]
v_mfma_f32_16x16x32_bf16 v[92:95], v[116:119], v[148:151], v[92:95]
s_waitcnt lgkmcnt(0)
v_mfma_f32_16x16x32_bf16 v[88:91], v[120:123], v[144:147], v[88:91]
v_mfma_f32_16x16x32_bf16 v[92:95], v[124:127], v[144:147], v[92:95]
s_mov_b32 s62, 4096
s_mov_b32 s63, 8192
s_nop 9
s_cmp_eq_u32 s52, 0
s_cbranch_scc1 L_w_11
s_cmp_eq_u32 s52, 1
s_cbranch_scc1 L_w_12
s_cmp_eq_u32 s52, 2
s_cbranch_scc1 L_w_13
ds_write_b128 v226, v[64:67] offset:6144
ds_write_b128 v226, v[68:71] offset:7168
ds_write_b128 v226, v[72:75] offset:14336
ds_write_b128 v226, v[76:79] offset:15360
ds_write_b128 v226, v[80:83] offset:22528
ds_write_b128 v226, v[84:87] offset:23552
s_branch L_wj_14
L_w_11:
ds_write_b128 v226, v[72:75] offset:8192
ds_write_b128 v226, v[76:79] offset:9216
ds_write_b128 v226, v[80:83] offset:16384
ds_write_b128 v226, v[84:87] offset:17408
ds_write_b128 v226, v[88:91] offset:24576
ds_write_b128 v226, v[92:95] offset:25600
s_branch L_wj_14
L_w_12:
ds_write_b128 v226, v[64:67] offset:2048
ds_write_b128 v226, v[68:71] offset:3072
ds_write_b128 v226, v[80:83] offset:18432
ds_write_b128 v226, v[84:87] offset:19456
ds_write_b128 v226, v[88:91] offset:26624
ds_write_b128 v226, v[92:95] offset:27648
s_branch L_wj_14
L_w_13:
ds_write_b128 v226, v[64:67] offset:4096
ds_write_b128 v226, v[68:71] offset:5120
ds_write_b128 v226, v[72:75] offset:12288
ds_write_b128 v226, v[76:79] offset:13312
ds_write_b128 v226, v[88:91] offset:28672
ds_write_b128 v226, v[92:95] offset:29696
L_wj_14:
s_waitcnt lgkmcnt(0)
s_barrier
s_cmp_eq_u32 s52, 0
s_cbranch_scc1 L_w_15
s_cmp_eq_u32 s52, 1
s_cbranch_scc1 L_w_16
s_cmp_eq_u32 s52, 2
s_cbranch_scc1 L_w_17
ds_read_b128 v[96:99], v246 offset:0
ds_read_b128 v[100:103], v246 offset:1024
ds_read_b128 v[104:107], v246 offset:2048
ds_read_b128 v[108:111], v246 offset:3072
ds_read_b128 v[112:115], v246 offset:4096
ds_read_b128 v[116:119], v246 offset:5120
s_waitcnt lgkmcnt(0)
v_pk_add_f32 v[96:97], v[96:97], v[104:105]
v_pk_add_f32 v[112:113], v[112:113], v[88:89]
v_pk_add_f32 v[98:99], v[98:99], v[106:107]
v_pk_add_f32 v[114:115], v[114:115], v[90:91]
v_pk_add_f32 v[100:101], v[100:101], v[108:109]
v_pk_add_f32 v[116:117], v[116:117], v[92:93]
v_pk_add_f32 v[102:103], v[102:103], v[110:111]
v_pk_add_f32 v[118:119], v[118:119], v[94:95]
s_branch L_wj_18
L_w_15:
ds_read_b128 v[104:107], v246 offset:2048
ds_read_b128 v[108:111], v246 offset:3072
ds_read_b128 v[112:115], v246 offset:4096
ds_read_b128 v[116:119], v246 offset:5120
ds_read_b128 v[120:123], v246 offset:6144
ds_read_b128 v[124:127], v246 offset:7168
s_waitcnt lgkmcnt(0)
v_pk_add_f32 v[96:97], v[64:65], v[104:105]
v_pk_add_f32 v[112:113], v[112:113], v[120:121]
v_pk_add_f32 v[98:99], v[66:67], v[106:107]
v_pk_add_f32 v[114:115], v[114:115], v[122:123]
v_pk_add_f32 v[100:101], v[68:69], v[108:109]
v_pk_add_f32 v[116:117], v[116:117], v[124:125]
v_pk_add_f32 v[102:103], v[70:71], v[110:111]
v_pk_add_f32 v[118:119], v[118:119], v[126:127]
s_branch L_wj_18
L_w_16:
ds_read_b128 v[96:99], v246 offset:0
ds_read_b128 v[100:103], v246 offset:1024
ds_read_b128 v[112:115], v246 offset:4096
ds_read_b128 v[116:119], v246 offset:5120
ds_read_b128 v[120:123], v246 offset:6144
ds_read_b128 v[124:127], v246 offset:7168
s_waitcnt lgkmcnt(0)
v_pk_add_f32 v[96:97], v[96:97], v[72:73]
v_pk_add_f32 v[112:113], v[112:113], v[120:121]
v_pk_add_f32 v[98:99], v[98:99], v[74:75]
v_pk_add_f32 v[114:115], v[114:115], v[122:123]
v_pk_add_f32 v[100:101], v[100:101], v[76:77]
v_pk_add_f32 v[116:117], v[116:117], v[124:125]
v_pk_add_f32 v[102:103], v[102:103], v[78:79]
v_pk_add_f32 v[118:119], v[118:119], v[126:127]
s_branch L_wj_18
L_w_17:
ds_read_b128 v[96:99], v246 offset:0
ds_read_b128 v[100:103], v246 offset:1024
ds_read_b128 v[104:107], v246 offset:2048
ds_read_b128 v[108:111], v246 offset:3072
ds_read_b128 v[120:123], v246 offset:6144
ds_read_b128 v[124:127], v246 offset:7168
s_waitcnt lgkmcnt(0)
v_pk_add_f32 v[96:97], v[96:97], v[104:105]
v_pk_add_f32 v[112:113], v[80:81], v[120:121]
v_pk_add_f32 v[98:99], v[98:99], v[106:107]
v_pk_add_f32 v[114:115], v[82:83], v[122:123]
v_pk_add_f32 v[100:101], v[100:101], v[108:109]
v_pk_add_f32 v[116:117], v[84:85], v[124:125]
v_pk_add_f32 v[102:103], v[102:103], v[110:111]
v_pk_add_f32 v[118:119], v[86:87], v[126:127]
L_wj_18:
v_cvt_pk_bf16_f32 v128, v96, v97
v_cvt_pk_bf16_f32 v129, v98, v99
v_cvt_pk_bf16_f32 v130, v100, v101
v_cvt_pk_bf16_f32 v131, v102, v103
v_cvt_pk_bf16_f32 v132, v112, v113
v_cvt_pk_bf16_f32 v133, v114, v115
v_cvt_pk_bf16_f32 v134, v116, v117
v_cvt_pk_bf16_f32 v135, v118, v119
v_mov_b32 v138, 0
v_mov_b32 v139, s53
v_permlane16_swap_b32 v128, v130
v_permlane16_swap_b32 v129, v131
v_permlane16_swap_b32 v132, v134
v_permlane16_swap_b32 v133, v135
v_mov_b32 v136, v131
v_mov_b32 v137, v135
v_mov_b32 v131, s53
v_mov_b32 v135, s53
buffer_store_dwordx4 v[136:139], v247, s[48:51], s63 offen sc1
buffer_store_dwordx4 v[128:131], v247, s[48:51], 0 offen sc1
buffer_store_dwordx4 v[132:135], v247, s[48:51], s62 offen sc1
v_lshrrev_b32 v26, 3, v1
v_and_b32 v30, 7, v1
v_lshrrev_b32 v31, 2, v1
v_and_b32 v31, 4, v31
v_xor_b32 v30, v30, v31
v_mul_u32_u24 v26, 3584, v26
v_lshl_add_u32 v26, v30, 4, v26
s_mul_i32 s60, s52, 1835008
s_lshl_b32 s61, s59, 7
s_add_u32 s60, s60, s61
v_add_u32 v26, s60, v26
s_waitcnt vmcnt(3)
ds_read_b64_tr_b16 a[0:1], v28 offset:0
ds_read_b64_tr_b16 a[2:3], v28 offset:512
ds_read_b64_tr_b16 a[4:5], v29 offset:0
ds_read_b64_tr_b16 a[6:7], v29 offset:512
ds_read_b64_tr_b16 a[8:9], v28 offset:2048
ds_read_b64_tr_b16 a[10:11], v28 offset:2560
ds_read_b64_tr_b16 a[12:13], v29 offset:2048
ds_read_b64_tr_b16 a[14:15], v29 offset:2560
ds_read_b64_tr_b16 a[16:17], v28 offset:4096
ds_read_b64_tr_b16 a[18:19], v28 offset:4608
ds_read_b64_tr_b16 a[20:21], v29 offset:4096
ds_read_b64_tr_b16 a[22:23], v29 offset:4608
ds_read_b64_tr_b16 a[24:25], v28 offset:6144
ds_read_b64_tr_b16 a[26:27], v28 offset:6656
ds_read_b64_tr_b16 a[28:29], v29 offset:6144
ds_read_b64_tr_b16 a[30:31], v29 offset:6656
ds_read_b64_tr_b16 a[32:33], v28 offset:8192
ds_read_b64_tr_b16 a[34:35], v28 offset:8704
ds_read_b64_tr_b16 a[36:37], v29 offset:8192
ds_read_b64_tr_b16 a[38:39], v29 offset:8704
ds_read_b64_tr_b16 a[40:41], v28 offset:10240
ds_read_b64_tr_b16 a[42:43], v28 offset:10752
ds_read_b64_tr_b16 a[44:45], v29 offset:10240
ds_read_b64_tr_b16 a[46:47], v29 offset:10752
ds_read_b64_tr_b16 a[48:49], v28 offset:12288
ds_read_b64_tr_b16 a[50:51], v28 offset:12800
ds_read_b64_tr_b16 a[52:53], v29 offset:12288
ds_read_b64_tr_b16 a[54:55], v29 offset:12800
ds_read_b64_tr_b16 a[56:57], v28 offset:14336
ds_read_b64_tr_b16 a[58:59], v28 offset:14848
ds_read_b64_tr_b16 a[60:61], v29 offset:14336
ds_read_b64_tr_b16 a[62:63], v29 offset:14848
s_waitcnt lgkmcnt(0)
s_barrier
s_and_b32 s60, s67, 0xc0
s_bfe_u32 s61, s67, 262146
s_add_u32 s60, s60, s61
s_and_b32 s61, s67, 1
s_lshl_b32 s61, s61, 5
s_add_u32 s60, s60, s61
s_bfe_u32 s61, s67, 65537
s_lshl_b32 s61, s61, 4
s_add_u32 s60, s60, s61
s_lshl_b32 s60, s60, 4
s_add_u32 s95, s96, 0
s_mov_b32 m0, s95
s_mov_b32 s92, 458752
buffer_load_dwordx4 v26, s[28:31], s92 offen offset:0 lds
s_mov_b32 s92, 486400
buffer_load_dwordx4 v26, s[28:31], s92 offen offset:1024 lds
s_add_u32 s64, s60, 4194304
s_add_u32 s65, s64, 4096
s_add_u32 s91, s64, 8192
s_mov_b32 s92, 514048
buffer_load_dwordx4 v26, s[28:31], s92 offen offset:2048 lds
s_mov_b32 s92, 541696
buffer_load_dwordx4 v26, s[28:31], s92 offen offset:3072 lds
v_mov_b32 v6, 0x80000000
v_mul_u32_u24 v19, 12288, v0
v_cmp_gt_u32 vcc, 224, v0
s_mul_i32 s61, s67, 7168
v_lshlrev_b32 v5, 4, v0
v_add_u32 v5, s61, v5
v_cndmask_b32 v19, v6, v19, vcc
v_cndmask_b32 v5, v6, v5, vcc
v_mov_b32 v29, v5
v_lshrrev_b32 v27, 5, v0
v_lshlrev_b32 v27, 18, v27
v_and_b32 v28, 31, v0
v_lshl_add_u32 v27, v28, 4, v27
s_lshl_b32 s61, s67, 9
v_add_u32 v27, s61, v27
v_cndmask_b32 v27, v6, v27, vcc
s_add_u32 s95, s96, 4096
s_mov_b32 m0, s95
s_mov_b32 s92, 573440
buffer_load_dwordx4 v26, s[28:31], s92 offen offset:0 lds
s_mov_b32 s92, 601088
buffer_load_dwordx4 v26, s[28:31], s92 offen offset:1024 lds
s_mov_b32 s92, 628736
buffer_load_dwordx4 v26, s[28:31], s92 offen offset:2048 lds
v_lshrrev_b32 v3, 4, v1
v_bfe_u32 v4, v1, 2, 2
v_and_b32 v5, 3, v1
v_lshrrev_b32 v6, 1, v3
v_lshlrev_b32 v6, 10, v6
v_lshl_add_u32 v6, v4, 7, v6
v_and_b32 v3, 1, v3
v_lshl_add_u32 v6, v3, 5, v6
v_lshrrev_b32 v7, 1, v5
v_lshl_add_u32 v6, v7, 4, v6
v_and_b32 v7, 1, v5
v_lshl_add_u32 v6, v7, 3, v6
v_lshrrev_b32 v7, 1, v4
v_add_u32 v6, s96, v6
v_lshl_add_u32 v24, v7, 6, v6
v_xor_b32 v7, 1, v7
v_lshl_add_u32 v25, v7, 6, v6
s_mov_b32 s92, 656384
buffer_load_dwordx4 v26, s[28:31], s92 offen offset:3072 lds
s_add_u32 s95, s96, 8192
s_mov_b32 m0, s95
s_mov_b32 s92, 688128
buffer_load_dwordx4 v26, s[28:31], s92 offen offset:0 lds
s_mov_b32 s92, 715776
buffer_load_dwordx4 v26, s[28:31], s92 offen offset:1024 lds
v_mov_b32 v44, 0
v_mov_b32 v45, 0
v_mov_b32 v46, 0
v_mov_b32 v47, 0
v_mov_b32 v48, 0
v_mov_b32 v49, 0
v_mov_b32 v50, 0
v_mov_b32 v51, 0
v_mov_b32 v52, 0
v_mov_b32 v53, 0
v_mov_b32 v54, 0
v_mov_b32 v55, 0
s_mov_b32 s92, 743424
buffer_load_dwordx4 v26, s[28:31], s92 offen offset:2048 lds
s_mov_b32 s92, 771072
buffer_load_dwordx4 v26, s[28:31], s92 offen offset:3072 lds
s_add_u32 s95, s96, 12288
s_mov_b32 m0, s95
s_mov_b32 s92, 802816
buffer_load_dwordx4 v26, s[28:31], s92 offen offset:0 lds
s_mov_b32 s92, 830464
buffer_load_dwordx4 v26, s[28:31], s92 offen offset:1024 lds
s_cmp_eq_u32 s52, 3
s_cselect_b32 s62, 0, -1
s_mov_b32 exec_hi, s62
buffer_load_dwordx4 v[44:47], v19, s[48:51], s64 offen offset:0 sc1
buffer_load_dwordx4 v[48:51], v19, s[48:51], s65 offen offset:0 sc1
buffer_load_dwordx4 v[52:55], v19, s[48:51], s91 offen offset:0 sc1
s_mov_b64 exec, -1
v_lshlrev_b32 v176, 16, v232
v_and_b32 v177, s66, v232
v_lshlrev_b32 v178, 16, v233
v_and_b32 v179, s66, v233
v_lshlrev_b32 v180, 16, v234
v_and_b32 v181, s66, v234
v_lshlrev_b32 v182, 16, v235
v_and_b32 v183, s66, v235
v_lshlrev_b32 v184, 16, v236
v_and_b32 v185, s66, v236
v_lshlrev_b32 v186, 16, v237
v_and_b32 v187, s66, v237
v_lshlrev_b32 v188, 16, v238
v_and_b32 v189, s66, v238
v_lshlrev_b32 v190, 16, v239
v_and_b32 v191, s66, v239
v_add_f32 v128, v176, v177
v_mul_f32 v136, v176, v176
v_fmac_f32 v136, v177, v177
v_add_f32 v129, v178, v179
v_mul_f32 v137, v178, v178
v_fmac_f32 v137, v179, v179
v_add_f32 v130, v180, v181
v_mul_f32 v138, v180, v180
v_fmac_f32 v138, v181, v181
v_add_f32 v131, v182, v183
v_mul_f32 v139, v182, v182
v_fmac_f32 v139, v183, v183
v_add_f32 v132, v184, v185
v_mul_f32 v140, v184, v184
v_fmac_f32 v140, v185, v185
v_add_f32 v133, v186, v187
v_mul_f32 v141, v186, v186
v_fmac_f32 v141, v187, v187
v_add_f32 v134, v188, v189
v_mul_f32 v142, v188, v188
v_fmac_f32 v142, v189, v189
v_add_f32 v135, v190, v191
v_mul_f32 v143, v190, v190
v_fmac_f32 v143, v191, v191
s_nop 1
v_permlane32_swap_b32 v128, v136
v_permlane32_swap_b32 v129, v137
v_permlane32_swap_b32 v130, v138
v_permlane32_swap_b32 v131, v139
v_permlane32_swap_b32 v132, v140
v_permlane32_swap_b32 v133, v141
v_permlane32_swap_b32 v134, v142
v_permlane32_swap_b32 v135, v143
v_add_f32 v128, v128, v136
v_add_f32 v129, v129, v137
v_add_f32 v130, v130, v138
v_add_f32 v131, v131, v139
v_add_f32 v132, v132, v140
v_add_f32 v133, v133, v141
v_add_f32 v134, v134, v142
v_add_f32 v135, v135, v143
s_nop 0
v_permlane16_swap_b32 v128, v132
v_permlane16_swap_b32 v129, v133
v_permlane16_swap_b32 v130, v134
v_permlane16_swap_b32 v131, v135
v_add_f32 v128, v128, v132
v_add_f32 v129, v129, v133
v_add_f32 v130, v130, v134
v_add_f32 v131, v131, v135
v_add_f32_dpp v128, v128, v128 row_ror:8 row_mask:0xf bank_mask:0xf
v_add_f32_dpp v129, v129, v129 row_ror:8 row_mask:0xf bank_mask:0xf
v_add_f32_dpp v130, v130, v130 row_ror:8 row_mask:0xf bank_mask:0xf
v_add_f32_dpp v131, v131, v131 row_ror:8 row_mask:0xf bank_mask:0xf
v_add_f32_dpp v128, v128, v128 row_ror:4 row_mask:0xf bank_mask:0xf
v_add_f32_dpp v129, v129, v129 row_ror:4 row_mask:0xf bank_mask:0xf
v_add_f32_dpp v130, v130, v130 row_ror:4 row_mask:0xf bank_mask:0xf
v_add_f32_dpp v131, v131, v131 row_ror:4 row_mask:0xf bank_mask:0xf
v_add_f32_dpp v128, v128, v128 row_ror:2 row_mask:0xf bank_mask:0xf
v_add_f32_dpp v129, v129, v129 row_ror:2 row_mask:0xf bank_mask:0xf
v_add_f32_dpp v130, v130, v130 row_ror:2 row_mask:0xf bank_mask:0xf
v_add_f32_dpp v131, v131, v131 row_ror:2 row_mask:0xf bank_mask:0xf
v_add_f32_dpp v128, v128, v128 row_ror:1 row_mask:0xf bank_mask:0xf
v_add_f32_dpp v129, v129, v129 row_ror:1 row_mask:0xf bank_mask:0xf
v_add_f32_dpp v130, v130, v130 row_ror:1 row_mask:0xf bank_mask:0xf
v_add_f32_dpp v131, v131, v131 row_ror:1 row_mask:0xf bank_mask:0xf
s_mov_b64 s[84:85], exec
s_mov_b32 exec_lo, 0x00010001
s_mov_b32 exec_hi, 0x00010001
ds_write_b32 v224, v128 offset:0
ds_write_b32 v224, v129 offset:16
ds_write_b32 v224, v130 offset:32
ds_write_b32 v224, v131 offset:48
s_mov_b64 exec, s[84:85]
s_mov_b32 s60, 0x3b124925
s_mov_b32 s61, 0x3727c5ac
s_waitcnt lgkmcnt(0)
s_barrier
ds_read_b128 v[128:131], v225 offset:0
ds_read_b128 v[132:135], v225 offset:128
s_waitcnt lgkmcnt(0)
v_add_f32 v128, v128, v129
v_add_f32 v132, v132, v133
v_add_f32 v130, v130, v131
v_add_f32 v134, v134, v135
v_add_f32 v128, v128, v130
v_add_f32 v132, v132, v134
v_mul_f32 v128, s60, v128
v_mul_f32 v132, s60, v132
v_fma_f32 v132, -v128, v128, v132
v_max_f32 v132, 0, v132
v_add_f32 v133, s61, v132
v_rsq_f32 v133, v133
s_nop 1
v_readlane_b32 s68, v128, 0
v_readlane_b32 s69, v133, 0
v_readlane_b32 s70, v128, 1
v_readlane_b32 s71, v133, 1
v_readlane_b32 s72, v128, 2
v_readlane_b32 s73, v133, 2
v_readlane_b32 s74, v128, 3
v_readlane_b32 s75, v133, 3
v_readlane_b32 s76, v128, 4
v_readlane_b32 s77, v133, 4
v_readlane_b32 s78, v128, 5
v_readlane_b32 s79, v133, 5
v_readlane_b32 s80, v128, 6
v_readlane_b32 s81, v133, 6
v_readlane_b32 s82, v128, 7
v_readlane_b32 s83, v133, 7
s_nop 1
v_pk_add_f32 v[192:193], v[176:177], s[68:69] op_sel:[0,0] op_sel_hi:[1,0] neg_lo:[0,1] neg_hi:[0,1]
v_pk_mul_f32 v[192:193], v[192:193], s[68:69] op_sel:[0,1] op_sel_hi:[1,1]
v_pk_add_f32 v[194:195], v[178:179], s[70:71] op_sel:[0,0] op_sel_hi:[1,0] neg_lo:[0,1] neg_hi:[0,1]
v_pk_mul_f32 v[194:195], v[194:195], s[70:71] op_sel:[0,1] op_sel_hi:[1,1]
v_pk_add_f32 v[196:197], v[180:181], s[72:73] op_sel:[0,0] op_sel_hi:[1,0] neg_lo:[0,1] neg_hi:[0,1]
v_pk_mul_f32 v[196:197], v[196:197], s[72:73] op_sel:[0,1] op_sel_hi:[1,1]
v_pk_add_f32 v[198:199], v[182:183], s[74:75] op_sel:[0,0] op_sel_hi:[1,0] neg_lo:[0,1] neg_hi:[0,1]
v_pk_mul_f32 v[198:199], v[198:199], s[74:75] op_sel:[0,1] op_sel_hi:[1,1]
v_pk_add_f32 v[200:201], v[184:185], s[76:77] op_sel:[0,0] op_sel_hi:[1,0] neg_lo:[0,1] neg_hi:[0,1]
v_pk_mul_f32 v[200:201], v[200:201], s[76:77] op_sel:[0,1] op_sel_hi:[1,1]
v_pk_add_f32 v[202:203], v[186:187], s[78:79] op_sel:[0,0] op_sel_hi:[1,0] neg_lo:[0,1] neg_hi:[0,1]
v_pk_mul_f32 v[202:203], v[202:203], s[78:79] op_sel:[0,1] op_sel_hi:[1,1]
v_pk_add_f32 v[204:205], v[188:189], s[80:81] op_sel:[0,0] op_sel_hi:[1,0] neg_lo:[0,1] neg_hi:[0,1]
v_pk_mul_f32 v[204:205], v[204:205], s[80:81] op_sel:[0,1] op_sel_hi:[1,1]
v_pk_add_f32 v[206:207], v[190:191], s[82:83] op_sel:[0,0] op_sel_hi:[1,0] neg_lo:[0,1] neg_hi:[0,1]
v_pk_mul_f32 v[206:207], v[206:207], s[82:83] op_sel:[0,1] op_sel_hi:[1,1]
v_lshlrev_b32 v128, 16, v42
v_and_b32 v129, s66, v42
v_and_b32 v208, s66, v168
v_and_b32 v209, s66, v169
v_pk_mul_f32 v[208:209], v[208:209], v[128:129]
v_lshlrev_b32 v210, 16, v168
v_lshlrev_b32 v211, 16, v169
v_pk_mul_f32 v[210:211], v[210:211], v[128:129]
v_and_b32 v212, s66, v162
v_and_b32 v213, s66, v166
v_pk_mul_f32 v[212:213], v[212:213], v[128:129]
v_lshlrev_b32 v214, 16, v162
v_lshlrev_b32 v215, 16, v166
v_pk_mul_f32 v[214:215], v[214:215], v[128:129]
v_and_b32 v216, s66, v161
v_and_b32 v217, s66, v165
v_pk_mul_f32 v[216:217], v[216:217], v[128:129]
v_lshlrev_b32 v218, 16, v161
v_lshlrev_b32 v219, 16, v165
v_pk_mul_f32 v[218:219], v[218:219], v[128:129]
v_and_b32 v220, s66, v160
v_and_b32 v221, s66, v164
v_pk_mul_f32 v[220:221], v[220:221], v[128:129]
v_lshlrev_b32 v222, 16, v160
v_lshlrev_b32 v223, 16, v164
v_pk_mul_f32 v[222:223], v[222:223], v[128:129]
s_mov_b32 exec_hi, s62
s_branch L_gathchk_21
L_gath_19:
buffer_load_dwordx4 v[44:47], v19, s[48:51], s64 offen offset:0 sc1
buffer_load_dwordx4 v[48:51], v19, s[48:51], s65 offen offset:0 sc1
buffer_load_dwordx4 v[52:55], v19, s[48:51], s91 offen offset:0 sc1
L_gathchk_21:
s_waitcnt vmcnt(0)
v_xor_b32 v47, s53, v47
v_xor_b32 v51, s53, v51
v_xor_b32 v55, s53, v55
v_or3_b32 v47, v47, v51, v55
v_cmp_ne_u32 vcc, 0, v47
s_nop 1
s_cbranch_vccz L_gathok_20
s_mov_b64 exec, vcc
s_sub_u32 s54, s54, 1
s_cmp_gt_i32 s54, 0
s_cbranch_scc1 L_gath_19
L_gathok_20:
s_mov_b64 exec, -1
s_mov_b32 s92, 858112
buffer_load_dwordx4 v26, s[28:31], s92 offen offset:2048 lds
s_mov_b32 s92, 885760
buffer_load_dwordx4 v26, s[28:31], s92 offen offset:3072 lds
s_add_u32 s95, s96, 16384
s_mov_b32 m0, s95
s_mov_b32 s92, 917504
buffer_load_dwordx4 v26, s[28:31], s92 offen offset:0 lds
s_mov_b32 s92, 945152
buffer_load_dwordx4 v26, s[28:31], s92 offen offset:1024 lds
s_mov_b32 s92, 972800
buffer_load_dwordx4 v26, s[28:31], s92 offen offset:2048 lds
s_mov_b32 s92, 1000448
buffer_load_dwordx4 v26, s[28:31], s92 offen offset:3072 lds
s_add_u32 s95, s96, 20480
s_mov_b32 m0, s95
s_mov_b32 s92, 1032192
buffer_load_dwordx4 v26, s[28:31], s92 offen offset:0 lds
s_mov_b32 s92, 1059840
buffer_load_dwordx4 v26, s[28:31], s92 offen offset:1024 lds
v_lshlrev_b32 v32, 16, v44
v_lshlrev_b32 v33, 16, v48
v_and_b32 v34, s66, v44
v_and_b32 v35, s66, v48
v_lshlrev_b32 v36, 16, v45
v_lshlrev_b32 v37, 16, v49
v_and_b32 v38, s66, v45
v_and_b32 v39, s66, v49
v_lshlrev_b32 v40, 16, v46
v_lshlrev_b32 v41, 16, v50
v_and_b32 v42, s66, v46
v_and_b32 v43, s66, v50
v_lshlrev_b32 v44, 16, v52
v_lshlrev_b32 v45, 16, v53
v_and_b32 v46, s66, v52
v_and_b32 v47, s66, v53
v_pk_add_f32 v[32:33], v[32:33], v[208:209]
v_pk_add_f32 v[34:35], v[34:35], v[210:211]
v_pk_add_f32 v[36:37], v[36:37], v[212:213]
v_pk_add_f32 v[38:39], v[38:39], v[214:215]
v_pk_add_f32 v[40:41], v[40:41], v[216:217]
v_pk_add_f32 v[42:43], v[42:43], v[218:219]
v_pk_add_f32 v[44:45], v[44:45], v[220:221]
v_pk_add_f32 v[46:47], v[46:47], v[222:223]
v_pk_fma_f32 v[32:33], v[192:193], v[32:33], v[176:177]
v_pk_fma_f32 v[34:35], v[194:195], v[34:35], v[178:179]
v_pk_fma_f32 v[36:37], v[196:197], v[36:37], v[180:181]
v_pk_fma_f32 v[38:39], v[198:199], v[38:39], v[182:183]
v_pk_fma_f32 v[40:41], v[200:201], v[40:41], v[184:185]
v_pk_fma_f32 v[42:43], v[202:203], v[42:43], v[186:187]
v_pk_fma_f32 v[44:45], v[204:205], v[44:45], v[188:189]
v_pk_fma_f32 v[46:47], v[206:207], v[46:47], v[190:191]
v_add_f32 v64, v32, v33
v_mul_f32 v72, v32, v32
v_fmac_f32 v72, v33, v33
v_add_f32 v65, v34, v35
v_mul_f32 v73, v34, v34
v_fmac_f32 v73, v35, v35
v_add_f32 v66, v36, v37
v_mul_f32 v74, v36, v36
v_fmac_f32 v74, v37, v37
v_add_f32 v67, v38, v39
v_mul_f32 v75, v38, v38
v_fmac_f32 v75, v39, v39
v_add_f32 v68, v40, v41
v_mul_f32 v76, v40, v40
v_fmac_f32 v76, v41, v41
v_add_f32 v69, v42, v43
v_mul_f32 v77, v42, v42
v_fmac_f32 v77, v43, v43
v_add_f32 v70, v44, v45
v_mul_f32 v78, v44, v44
v_fmac_f32 v78, v45, v45
v_add_f32 v71, v46, v47
v_mul_f32 v79, v46, v46
v_fmac_f32 v79, v47, v47
v_permlane32_swap_b32 v64, v72
v_permlane32_swap_b32 v65, v73
v_permlane32_swap_b32 v66, v74
v_permlane32_swap_b32 v67, v75
v_permlane32_swap_b32 v68, v76
v_permlane32_swap_b32 v69, v77
v_permlane32_swap_b32 v70, v78
v_permlane32_swap_b32 v71, v79
v_add_f32 v64, v64, v72
v_add_f32 v65, v65, v73
v_add_f32 v66, v66, v74
v_add_f32 v67, v67, v75
v_add_f32 v68, v68, v76
v_add_f32 v69, v69, v77
v_add_f32 v70, v70, v78
v_add_f32 v71, v71, v79
s_nop 0
v_permlane16_swap_b32 v64, v68
v_permlane16_swap_b32 v65, v69
v_permlane16_swap_b32 v66, v70
v_permlane16_swap_b32 v67, v71
v_add_f32 v64, v64, v68
v_add_f32 v65, v65, v69
v_add_f32 v66, v66, v70
v_add_f32 v67, v67, v71
v_add_f32_dpp v64, v64, v64 row_ror:8 row_mask:0xf bank_mask:0xf
v_add_f32_dpp v65, v65, v65 row_ror:8 row_mask:0xf bank_mask:0xf
v_add_f32_dpp v66, v66, v66 row_ror:8 row_mask:0xf bank_mask:0xf
v_add_f32_dpp v67, v67, v67 row_ror:8 row_mask:0xf bank_mask:0xf
v_add_f32_dpp v64, v64, v64 row_ror:4 row_mask:0xf bank_mask:0xf
v_add_f32_dpp v65, v65, v65 row_ror:4 row_mask:0xf bank_mask:0xf
v_add_f32_dpp v66, v66, v66 row_ror:4 row_mask:0xf bank_mask:0xf
v_add_f32_dpp v67, v67, v67 row_ror:4 row_mask:0xf bank_mask:0xf
v_add_f32_dpp v64, v64, v64 row_ror:2 row_mask:0xf bank_mask:0xf
v_add_f32_dpp v65, v65, v65 row_ror:2 row_mask:0xf bank_mask:0xf
v_add_f32_dpp v66, v66, v66 row_ror:2 row_mask:0xf bank_mask:0xf
v_add_f32_dpp v67, v67, v67 row_ror:2 row_mask:0xf bank_mask:0xf
v_add_f32_dpp v64, v64, v64 row_ror:1 row_mask:0xf bank_mask:0xf
v_add_f32_dpp v65, v65, v65 row_ror:1 row_mask:0xf bank_mask:0xf
v_add_f32_dpp v66, v66, v66 row_ror:1 row_mask:0xf bank_mask:0xf
v_add_f32_dpp v67, v67, v67 row_ror:1 row_mask:0xf bank_mask:0xf
s_mov_b64 s[84:85], exec
s_mov_b32 exec_lo, 0x00010001
s_mov_b32 exec_hi, 0x00010001
ds_write_b32 v224, v64 offset:256
ds_write_b32 v224, v65 offset:272
ds_write_b32 v224, v66 offset:288
ds_write_b32 v224, v67 offset:304
s_mov_b64 exec, s[84:85]
s_mov_b32 s60, 0x3b124925
s_mov_b32 s61, 0x3727c5ac
s_waitcnt lgkmcnt(0)
s_barrier
ds_read_b128 v[64:67], v225 offset:256
ds_read_b128 v[68:71], v225 offset:384
v_cvt_pk_bf16_f32 v16, v32, v33
v_cvt_pk_bf16_f32 v17, v34, v35
v_cvt_pk_bf16_f32 v18, v36, v37
v_cvt_pk_bf16_f32 v19, v38, v39
v_cvt_pk_bf16_f32 v20, v40, v41
v_cvt_pk_bf16_f32 v21, v42, v43
v_cvt_pk_bf16_f32 v22, v44, v45
v_cvt_pk_bf16_f32 v23, v46, v47
s_waitcnt lgkmcnt(0)
v_add_f32 v64, v64, v65
v_add_f32 v68, v68, v69
v_add_f32 v66, v66, v67
v_add_f32 v70, v70, v71
v_add_f32 v64, v64, v66
v_add_f32 v68, v68, v70
v_mul_f32 v64, s60, v64
v_mul_f32 v68, s60, v68
v_fma_f32 v68, -v64, v64, v68
v_max_f32 v68, 0, v68
v_add_f32 v69, s61, v68
v_rsq_f32 v69, v69
s_nop 0
v_mul_f32 v70, v69, v69
v_mul_f32 v70, v70, v68
v_add_f32 v70, s61, v70
v_rsq_f32 v70, v70
s_nop 0
v_mul_f32 v69, v69, v70
s_nop 1
v_readlane_b32 s68, v64, 0
v_readlane_b32 s69, v69, 0
v_readlane_b32 s70, v64, 1
v_readlane_b32 s71, v69, 1
v_readlane_b32 s72, v64, 2
v_readlane_b32 s73, v69, 2
v_readlane_b32 s74, v64, 3
v_readlane_b32 s75, v69, 3
v_readlane_b32 s76, v64, 4
v_readlane_b32 s77, v69, 4
v_readlane_b32 s78, v64, 5
v_readlane_b32 s79, v69, 5
v_readlane_b32 s80, v64, 6
v_readlane_b32 s81, v69, 6
v_readlane_b32 s82, v64, 7
v_readlane_b32 s83, v69, 7
s_nop 1
v_pk_add_f32 v[32:33], v[32:33], s[68:69] op_sel:[0,0] op_sel_hi:[1,0] neg_lo:[0,1] neg_hi:[0,1]
v_pk_mul_f32 v[32:33], v[32:33], s[68:69] op_sel:[0,1] op_sel_hi:[1,1]
v_pk_add_f32 v[34:35], v[34:35], s[70:71] op_sel:[0,0] op_sel_hi:[1,0] neg_lo:[0,1] neg_hi:[0,1]
v_pk_mul_f32 v[34:35], v[34:35], s[70:71] op_sel:[0,1] op_sel_hi:[1,1]
v_pk_add_f32 v[36:37], v[36:37], s[72:73] op_sel:[0,0] op_sel_hi:[1,0] neg_lo:[0,1] neg_hi:[0,1]
v_pk_mul_f32 v[36:37], v[36:37], s[72:73] op_sel:[0,1] op_sel_hi:[1,1]
v_pk_add_f32 v[38:39], v[38:39], s[74:75] op_sel:[0,0] op_sel_hi:[1,0] neg_lo:[0,1] neg_hi:[0,1]
v_pk_mul_f32 v[38:39], v[38:39], s[74:75] op_sel:[0,1] op_sel_hi:[1,1]
v_pk_add_f32 v[40:41], v[40:41], s[76:77] op_sel:[0,0] op_sel_hi:[1,0] neg_lo:[0,1] neg_hi:[0,1]
v_pk_mul_f32 v[40:41], v[40:41], s[76:77] op_sel:[0,1] op_sel_hi:[1,1]
v_pk_add_f32 v[42:43], v[42:43], s[78:79] op_sel:[0,0] op_sel_hi:[1,0] neg_lo:[0,1] neg_hi:[0,1]
v_pk_mul_f32 v[42:43], v[42:43], s[78:79] op_sel:[0,1] op_sel_hi:[1,1]
v_pk_add_f32 v[44:45], v[44:45], s[80:81] op_sel:[0,0] op_sel_hi:[1,0] neg_lo:[0,1] neg_hi:[0,1]
v_pk_mul_f32 v[44:45], v[44:45], s[80:81] op_sel:[0,1] op_sel_hi:[1,1]
v_pk_add_f32 v[46:47], v[46:47], s[82:83] op_sel:[0,0] op_sel_hi:[1,0] neg_lo:[0,1] neg_hi:[0,1]
v_pk_mul_f32 v[46:47], v[46:47], s[82:83] op_sel:[0,1] op_sel_hi:[1,1]
v_cvt_pk_bf16_f32 v8, v32, v34
v_cvt_pk_bf16_f32 v9, v36, v38
v_cvt_pk_bf16_f32 v10, v40, v42
v_cvt_pk_bf16_f32 v11, v44, v46
v_cvt_pk_bf16_f32 v12, v33, v35
v_cvt_pk_bf16_f32 v13, v37, v39
v_cvt_pk_bf16_f32 v14, v41, v43
v_cvt_pk_bf16_f32 v15, v45, v47
s_mov_b32 s62, 7340032
s_mov_b32 s63, 7471104
buffer_store_dwordx4 v[8:11], v27, s[48:51], s62 offen sc1
buffer_store_dwordx4 v[12:15], v27, s[48:51], s63 offen sc1
s_mov_b32 s63, 9437184
buffer_store_dwordx4 v[16:19], v29, s[48:51], s63 offen sc1
buffer_store_dwordx4 v[20:23], v29, s[48:51], s63 offen offset:3584 sc1
s_mov_b32 s92, 1087488
buffer_load_dwordx4 v26, s[28:31], s92 offen offset:2048 lds
s_mov_b32 s92, 1115136
buffer_load_dwordx4 v26, s[28:31], s92 offen offset:3072 lds
s_add_u32 s95, s96, 24576
s_mov_b32 m0, s95
s_mov_b32 s92, 1146880
buffer_load_dwordx4 v26, s[28:31], s92 offen offset:0 lds
s_mov_b32 s92, 1174528
buffer_load_dwordx4 v26, s[28:31], s92 offen offset:1024 lds
s_mov_b32 s92, 1202176
buffer_load_dwordx4 v26, s[28:31], s92 offen offset:2048 lds
s_mov_b32 s92, 1229824
buffer_load_dwordx4 v26, s[28:31], s92 offen offset:3072 lds
s_add_u32 s95, s96, 28672
s_mov_b32 m0, s95
s_mov_b32 s92, 1261568
buffer_load_dwordx4 v26, s[28:31], s92 offen offset:0 lds
s_mov_b32 s92, 1289216
buffer_load_dwordx4 v26, s[28:31], s92 offen offset:1024 lds
s_mov_b32 s92, 1316864
buffer_load_dwordx4 v26, s[28:31], s92 offen offset:2048 lds
s_mov_b32 s92, 1344512
buffer_load_dwordx4 v26, s[28:31], s92 offen offset:3072 lds
s_waitcnt vmcnt(10)
s_lshl_b32 s60, s67, 2
s_add_u32 s60, s60, s52
s_mul_i32 s60, s60, 64
s_add_u32 s60, s60, 131072
v_mov_b32 v2, s60
v_mov_b32 v3, s53
s_mov_b64 s[84:85], exec
s_mov_b64 exec, 1
buffer_store_dword v3, v2, s[48:51], 0 offen sc1
s_mov_b64 exec, s[84:85]
ds_read_b64_tr_b16 a[64:65], v24 offset:0
ds_read_b64_tr_b16 a[66:67], v24 offset:512
ds_read_b64_tr_b16 a[68:69], v25 offset:0
ds_read_b64_tr_b16 a[70:71], v25 offset:512
ds_read_b64_tr_b16 a[72:73], v24 offset:2048
ds_read_b64_tr_b16 a[74:75], v24 offset:2560
ds_read_b64_tr_b16 a[76:77], v25 offset:2048
ds_read_b64_tr_b16 a[78:79], v25 offset:2560
ds_read_b64_tr_b16 a[80:81], v24 offset:4096
ds_read_b64_tr_b16 a[82:83], v24 offset:4608
ds_read_b64_tr_b16 a[84:85], v25 offset:4096
ds_read_b64_tr_b16 a[86:87], v25 offset:4608
ds_read_b64_tr_b16 a[88:89], v24 offset:6144
ds_read_b64_tr_b16 a[90:91], v24 offset:6656
ds_read_b64_tr_b16 a[92:93], v25 offset:6144
ds_read_b64_tr_b16 a[94:95], v25 offset:6656
ds_read_b64_tr_b16 a[96:97], v24 offset:8192
ds_read_b64_tr_b16 a[98:99], v24 offset:8704
ds_read_b64_tr_b16 a[100:101], v25 offset:8192
ds_read_b64_tr_b16 a[102:103], v25 offset:8704
ds_read_b64_tr_b16 a[104:105], v24 offset:10240
ds_read_b64_tr_b16 a[106:107], v24 offset:10752
ds_read_b64_tr_b16 a[108:109], v25 offset:10240
ds_read_b64_tr_b16 a[110:111], v25 offset:10752
ds_read_b64_tr_b16 a[112:113], v24 offset:12288
ds_read_b64_tr_b16 a[114:115], v24 offset:12800
ds_read_b64_tr_b16 a[116:117], v25 offset:12288
ds_read_b64_tr_b16 a[118:119], v25 offset:12800
ds_read_b64_tr_b16 a[120:121], v24 offset:14336
ds_read_b64_tr_b16 a[122:123], v24 offset:14848
ds_read_b64_tr_b16 a[124:125], v25 offset:14336
ds_read_b64_tr_b16 a[126:127], v25 offset:14848
s_waitcnt lgkmcnt(0)
s_branch L_convend_5
L_noconv_4:
s_cmp_lt_u32 s56, 28
s_cbranch_scc1 L_nopf_22
s_lshl_b32 s61, s55, 2
s_mul_i32 s62, s55, 3
s_add_u32 s62, s62, 4
s_cmp_lt_u32 s55, 4
s_cselect_b32 s61, s61, s62
s_lshl_b32 s61, s61, 7
s_sub_u32 s60, s56, 28
s_mul_i32 s60, s60, 512
s_mul_i32 s62, s52, 96
s_add_u32 s60, s60, s62
s_add_u32 s60, s60, 128
s_mul_i32 s60, s60, 3584
s_add_u32 s60, s60, s61
v_lshrrev_b32 v2, 5, v1
v_mul_u32_u24 v2, 3584, v2
v_and_b32 v3, 31, v1
v_lshl_add_u32 v2, v3, 4, v2
v_add_u32 v2, s60, v2
s_mov_b32 s92, 0
buffer_load_dwordx4 a[0:3], v2, s[28:31], s92 offen
s_mov_b32 s92, 7168
buffer_load_dwordx4 a[4:7], v2, s[28:31], s92 offen
s_mov_b32 s92, 14336
buffer_load_dwordx4 a[8:11], v2, s[28:31], s92 offen
s_mov_b32 s92, 21504
buffer_load_dwordx4 a[12:15], v2, s[28:31], s92 offen
s_mov_b32 s92, 28672
buffer_load_dwordx4 a[16:19], v2, s[28:31], s92 offen
s_mov_b32 s92, 35840
buffer_load_dwordx4 a[20:23], v2, s[28:31], s92 offen
s_mov_b32 s92, 43008
buffer_load_dwordx4 a[24:27], v2, s[28:31], s92 offen
s_mov_b32 s92, 50176
buffer_load_dwordx4 a[28:31], v2, s[28:31], s92 offen
s_mov_b32 s92, 57344
buffer_load_dwordx4 a[32:35], v2, s[28:31], s92 offen
s_mov_b32 s92, 64512
buffer_load_dwordx4 a[36:39], v2, s[28:31], s92 offen
s_mov_b32 s92, 71680
buffer_load_dwordx4 a[40:43], v2, s[28:31], s92 offen
s_mov_b32 s92, 78848
buffer_load_dwordx4 a[44:47], v2, s[28:31], s92 offen
s_mov_b32 s92, 86016
buffer_load_dwordx4 a[48:51], v2, s[28:31], s92 offen
s_mov_b32 s92, 93184
buffer_load_dwordx4 a[52:55], v2, s[28:31], s92 offen
s_mov_b32 s92, 100352
buffer_load_dwordx4 a[56:59], v2, s[28:31], s92 offen
s_mov_b32 s92, 107520
buffer_load_dwordx4 a[60:63], v2, s[28:31], s92 offen
s_mov_b32 s92, 114688
buffer_load_dwordx4 a[0:3], v2, s[28:31], s92 offen
s_mov_b32 s92, 121856
buffer_load_dwordx4 a[4:7], v2, s[28:31], s92 offen
s_mov_b32 s92, 129024
buffer_load_dwordx4 a[8:11], v2, s[28:31], s92 offen
s_mov_b32 s92, 136192
buffer_load_dwordx4 a[12:15], v2, s[28:31], s92 offen
s_mov_b32 s92, 143360
buffer_load_dwordx4 a[16:19], v2, s[28:31], s92 offen
s_mov_b32 s92, 150528
buffer_load_dwordx4 a[20:23], v2, s[28:31], s92 offen
s_mov_b32 s92, 157696
buffer_load_dwordx4 a[24:27], v2, s[28:31], s92 offen
s_mov_b32 s92, 164864
buffer_load_dwordx4 a[28:31], v2, s[28:31], s92 offen
s_mov_b32 s92, 172032
buffer_load_dwordx4 a[32:35], v2, s[28:31], s92 offen
s_mov_b32 s92, 179200
buffer_load_dwordx4 a[36:39], v2, s[28:31], s92 offen
s_mov_b32 s92, 186368
buffer_load_dwordx4 a[40:43], v2, s[28:31], s92 offen
s_mov_b32 s92, 193536
buffer_load_dwordx4 a[44:47], v2, s[28:31], s92 offen
s_mov_b32 s92, 200704
buffer_load_dwordx4 a[48:51], v2, s[28:31], s92 offen
s_mov_b32 s92, 207872
buffer_load_dwordx4 a[52:55], v2, s[28:31], s92 offen
s_mov_b32 s92, 215040
buffer_load_dwordx4 a[56:59], v2, s[28:31], s92 offen
s_mov_b32 s92, 222208
buffer_load_dwordx4 a[60:63], v2, s[28:31], s92 offen
s_mov_b32 s92, 229376
buffer_load_dwordx4 a[0:3], v2, s[28:31], s92 offen
s_mov_b32 s92, 236544
buffer_load_dwordx4 a[4:7], v2, s[28:31], s92 offen
s_mov_b32 s92, 243712
buffer_load_dwordx4 a[8:11], v2, s[28:31], s92 offen
s_mov_b32 s92, 250880
buffer_load_dwordx4 a[12:15], v2, s[28:31], s92 offen
s_mov_b32 s92, 258048
buffer_load_dwordx4 a[16:19], v2, s[28:31], s92 offen
s_mov_b32 s92, 265216
buffer_load_dwordx4 a[20:23], v2, s[28:31], s92 offen
s_mov_b32 s92, 272384
buffer_load_dwordx4 a[24:27], v2, s[28:31], s92 offen
s_mov_b32 s92, 279552
buffer_load_dwordx4 a[28:31], v2, s[28:31], s92 offen
s_mov_b32 s92, 286720
buffer_load_dwordx4 a[32:35], v2, s[28:31], s92 offen
s_mov_b32 s92, 293888
buffer_load_dwordx4 a[36:39], v2, s[28:31], s92 offen
s_mov_b32 s92, 301056
buffer_load_dwordx4 a[40:43], v2, s[28:31], s92 offen
s_mov_b32 s92, 308224
buffer_load_dwordx4 a[44:47], v2, s[28:31], s92 offen
s_mov_b32 s92, 315392
buffer_load_dwordx4 a[48:51], v2, s[28:31], s92 offen
s_mov_b32 s92, 322560
buffer_load_dwordx4 a[52:55], v2, s[28:31], s92 offen
s_mov_b32 s92, 329728
buffer_load_dwordx4 a[56:59], v2, s[28:31], s92 offen
s_mov_b32 s92, 336896
buffer_load_dwordx4 a[60:63], v2, s[28:31], s92 offen
L_nopf_22:
s_waitcnt vmcnt(48)
v_lshlrev_b32 v176, 16, v232
v_and_b32 v177, s66, v232
v_lshlrev_b32 v178, 16, v233
v_and_b32 v179, s66, v233
v_lshlrev_b32 v180, 16, v234
v_and_b32 v181, s66, v234
v_lshlrev_b32 v182, 16, v235
v_and_b32 v183, s66, v235
v_lshlrev_b32 v184, 16, v236
v_and_b32 v185, s66, v236
v_lshlrev_b32 v186, 16, v237
v_and_b32 v187, s66, v237
v_lshlrev_b32 v188, 16, v238
v_and_b32 v189, s66, v238
v_lshlrev_b32 v190, 16, v239
v_and_b32 v191, s66, v239
v_add_f32 v128, v176, v177
v_mul_f32 v136, v176, v176
v_fmac_f32 v136, v177, v177
v_add_f32 v129, v178, v179
v_mul_f32 v137, v178, v178
v_fmac_f32 v137, v179, v179
v_add_f32 v130, v180, v181
v_mul_f32 v138, v180, v180
v_fmac_f32 v138, v181, v181
v_add_f32 v131, v182, v183
v_mul_f32 v139, v182, v182
v_fmac_f32 v139, v183, v183
v_add_f32 v132, v184, v185
v_mul_f32 v140, v184, v184
v_fmac_f32 v140, v185, v185
v_add_f32 v133, v186, v187
v_mul_f32 v141, v186, v186
v_fmac_f32 v141, v187, v187
v_add_f32 v134, v188, v189
v_mul_f32 v142, v188, v188
v_fmac_f32 v142, v189, v189
v_add_f32 v135, v190, v191
v_mul_f32 v143, v190, v190
v_fmac_f32 v143, v191, v191
s_nop 1
v_permlane32_swap_b32 v128, v136
v_permlane32_swap_b32 v129, v137
v_permlane32_swap_b32 v130, v138
v_permlane32_swap_b32 v131, v139
v_permlane32_swap_b32 v132, v140
v_permlane32_swap_b32 v133, v141
v_permlane32_swap_b32 v134, v142
v_permlane32_swap_b32 v135, v143
v_add_f32 v128, v128, v136
v_add_f32 v129, v129, v137
v_add_f32 v130, v130, v138
v_add_f32 v131, v131, v139
v_add_f32 v132, v132, v140
v_add_f32 v133, v133, v141
v_add_f32 v134, v134, v142
v_add_f32 v135, v135, v143
s_nop 0
v_permlane16_swap_b32 v128, v132
v_permlane16_swap_b32 v129, v133
v_permlane16_swap_b32 v130, v134
v_permlane16_swap_b32 v131, v135
v_add_f32 v128, v128, v132
v_add_f32 v129, v129, v133
v_add_f32 v130, v130, v134
v_add_f32 v131, v131, v135
v_add_f32_dpp v128, v128, v128 row_ror:8 row_mask:0xf bank_mask:0xf
v_add_f32_dpp v129, v129, v129 row_ror:8 row_mask:0xf bank_mask:0xf
v_add_f32_dpp v130, v130, v130 row_ror:8 row_mask:0xf bank_mask:0xf
v_add_f32_dpp v131, v131, v131 row_ror:8 row_mask:0xf bank_mask:0xf
v_add_f32_dpp v128, v128, v128 row_ror:4 row_mask:0xf bank_mask:0xf
v_add_f32_dpp v129, v129, v129 row_ror:4 row_mask:0xf bank_mask:0xf
v_add_f32_dpp v130, v130, v130 row_ror:4 row_mask:0xf bank_mask:0xf
v_add_f32_dpp v131, v131, v131 row_ror:4 row_mask:0xf bank_mask:0xf
v_add_f32_dpp v128, v128, v128 row_ror:2 row_mask:0xf bank_mask:0xf
v_add_f32_dpp v129, v129, v129 row_ror:2 row_mask:0xf bank_mask:0xf
v_add_f32_dpp v130, v130, v130 row_ror:2 row_mask:0xf bank_mask:0xf
v_add_f32_dpp v131, v131, v131 row_ror:2 row_mask:0xf bank_mask:0xf
v_add_f32_dpp v128, v128, v128 row_ror:1 row_mask:0xf bank_mask:0xf
v_add_f32_dpp v129, v129, v129 row_ror:1 row_mask:0xf bank_mask:0xf
v_add_f32_dpp v130, v130, v130 row_ror:1 row_mask:0xf bank_mask:0xf
v_add_f32_dpp v131, v131, v131 row_ror:1 row_mask:0xf bank_mask:0xf
s_mov_b64 s[84:85], exec
s_mov_b32 exec_lo, 0x00010001
s_mov_b32 exec_hi, 0x00010001
ds_write_b32 v224, v128 offset:0
ds_write_b32 v224, v129 offset:16
ds_write_b32 v224, v130 offset:32
ds_write_b32 v224, v131 offset:48
s_mov_b64 exec, s[84:85]
s_mov_b32 s60, 0x3b124925
s_mov_b32 s61, 0x3727c5ac
s_waitcnt lgkmcnt(0)
s_barrier
ds_read_b128 v[128:131], v225 offset:0
ds_read_b128 v[132:135], v225 offset:128
s_waitcnt lgkmcnt(0)
v_add_f32 v128, v128, v129
v_add_f32 v132, v132, v133
v_add_f32 v130, v130, v131
v_add_f32 v134, v134, v135
v_add_f32 v128, v128, v130
v_add_f32 v132, v132, v134
v_mul_f32 v128, s60, v128
v_mul_f32 v132, s60, v132
v_fma_f32 v132, -v128, v128, v132
v_max_f32 v132, 0, v132
v_add_f32 v133, s61, v132
v_rsq_f32 v133, v133
s_nop 1
v_readlane_b32 s68, v128, 0
v_readlane_b32 s69, v133, 0
v_readlane_b32 s70, v128, 1
v_readlane_b32 s71, v133, 1
v_readlane_b32 s72, v128, 2
v_readlane_b32 s73, v133, 2
v_readlane_b32 s74, v128, 3
v_readlane_b32 s75, v133, 3
v_readlane_b32 s76, v128, 4
v_readlane_b32 s77, v133, 4
v_readlane_b32 s78, v128, 5
v_readlane_b32 s79, v133, 5
v_readlane_b32 s80, v128, 6
v_readlane_b32 s81, v133, 6
v_readlane_b32 s82, v128, 7
v_readlane_b32 s83, v133, 7
s_nop 1
v_pk_add_f32 v[192:193], v[176:177], s[68:69] op_sel:[0,0] op_sel_hi:[1,0] neg_lo:[0,1] neg_hi:[0,1]
v_pk_mul_f32 v[192:193], v[192:193], s[68:69] op_sel:[0,1] op_sel_hi:[1,1]
v_pk_add_f32 v[194:195], v[178:179], s[70:71] op_sel:[0,0] op_sel_hi:[1,0] neg_lo:[0,1] neg_hi:[0,1]
v_pk_mul_f32 v[194:195], v[194:195], s[70:71] op_sel:[0,1] op_sel_hi:[1,1]
v_pk_add_f32 v[196:197], v[180:181], s[72:73] op_sel:[0,0] op_sel_hi:[1,0] neg_lo:[0,1] neg_hi:[0,1]
v_pk_mul_f32 v[196:197], v[196:197], s[72:73] op_sel:[0,1] op_sel_hi:[1,1]
v_pk_add_f32 v[198:199], v[182:183], s[74:75] op_sel:[0,0] op_sel_hi:[1,0] neg_lo:[0,1] neg_hi:[0,1]
v_pk_mul_f32 v[198:199], v[198:199], s[74:75] op_sel:[0,1] op_sel_hi:[1,1]
v_pk_add_f32 v[200:201], v[184:185], s[76:77] op_sel:[0,0] op_sel_hi:[1,0] neg_lo:[0,1] neg_hi:[0,1]
v_pk_mul_f32 v[200:201], v[200:201], s[76:77] op_sel:[0,1] op_sel_hi:[1,1]
v_pk_add_f32 v[202:203], v[186:187], s[78:79] op_sel:[0,0] op_sel_hi:[1,0] neg_lo:[0,1] neg_hi:[0,1]
v_pk_mul_f32 v[202:203], v[202:203], s[78:79] op_sel:[0,1] op_sel_hi:[1,1]
v_pk_add_f32 v[204:205], v[188:189], s[80:81] op_sel:[0,0] op_sel_hi:[1,0] neg_lo:[0,1] neg_hi:[0,1]
v_pk_mul_f32 v[204:205], v[204:205], s[80:81] op_sel:[0,1] op_sel_hi:[1,1]
v_pk_add_f32 v[206:207], v[190:191], s[82:83] op_sel:[0,0] op_sel_hi:[1,0] neg_lo:[0,1] neg_hi:[0,1]
v_pk_mul_f32 v[206:207], v[206:207], s[82:83] op_sel:[0,1] op_sel_hi:[1,1]
v_lshlrev_b32 v128, 16, v42
v_and_b32 v129, s66, v42
v_and_b32 v208, s66, v168
v_and_b32 v209, s66, v169
v_pk_mul_f32 v[208:209], v[208:209], v[128:129]
v_lshlrev_b32 v210, 16, v168
v_lshlrev_b32 v211, 16, v169
v_pk_mul_f32 v[210:211], v[210:211], v[128:129]
v_and_b32 v212, s66, v162
v_and_b32 v213, s66, v166
v_pk_mul_f32 v[212:213], v[212:213], v[128:129]
v_lshlrev_b32 v214, 16, v162
v_lshlrev_b32 v215, 16, v166
v_pk_mul_f32 v[214:215], v[214:215], v[128:129]
v_and_b32 v216, s66, v161
v_and_b32 v217, s66, v165
v_pk_mul_f32 v[216:217], v[216:217], v[128:129]
v_lshlrev_b32 v218, 16, v161
v_lshlrev_b32 v219, 16, v165
v_pk_mul_f32 v[218:219], v[218:219], v[128:129]
v_and_b32 v220, s66, v160
v_and_b32 v221, s66, v164
v_pk_mul_f32 v[220:221], v[220:221], v[128:129]
v_lshlrev_b32 v222, 16, v160
v_lshlrev_b32 v223, 16, v164
v_pk_mul_f32 v[222:223], v[222:223], v[128:129]
s_and_b32 s60, s67, 0xc0
s_bfe_u32 s61, s67, 262146
s_add_u32 s60, s60, s61
s_and_b32 s61, s67, 1
s_lshl_b32 s61, s61, 5
s_add_u32 s60, s60, s61
s_bfe_u32 s61, s67, 65537
s_lshl_b32 s61, s61, 4
s_add_u32 s60, s60, s61
s_lshl_b32 s60, s60, 4
s_add_u32 s64, s60, 4194304
s_add_u32 s65, s64, 4096
s_add_u32 s91, s64, 8192
v_mov_b32 v6, 0x80000000
v_mul_u32_u24 v19, 12288, v0
v_cmp_gt_u32 vcc, 224, v0
s_mul_i32 s61, s67, 7168
v_lshlrev_b32 v5, 4, v0
v_add_u32 v5, s61, v5
v_cndmask_b32 v19, v6, v19, vcc
v_cndmask_b32 v5, v6, v5, vcc
v_mov_b32 v29, v5
v_lshrrev_b32 v27, 5, v0
v_lshlrev_b32 v27, 18, v27
v_and_b32 v28, 31, v0
v_lshl_add_u32 v27, v28, 4, v27
s_lshl_b32 s61, s67, 9
v_add_u32 v27, s61, v27
v_cndmask_b32 v27, v6, v27, vcc
v_lshrrev_b32 v3, 4, v1
v_bfe_u32 v4, v1, 2, 2
v_and_b32 v5, 3, v1
v_lshrrev_b32 v6, 1, v3
v_lshlrev_b32 v6, 10, v6
v_lshl_add_u32 v6, v4, 7, v6
v_and_b32 v3, 1, v3
v_lshl_add_u32 v6, v3, 5, v6
v_lshrrev_b32 v7, 1, v5
v_lshl_add_u32 v6, v7, 4, v6
v_and_b32 v7, 1, v5
v_lshl_add_u32 v6, v7, 3, v6
v_lshrrev_b32 v7, 1, v4
v_add_u32 v6, s96, v6
v_lshl_add_u32 v24, v7, 6, v6
v_xor_b32 v7, 1, v7
v_lshl_add_u32 v25, v7, 6, v6
v_mov_b32 v44, 0
v_mov_b32 v45, 0
v_mov_b32 v46, 0
v_mov_b32 v47, 0
v_mov_b32 v48, 0
v_mov_b32 v49, 0
v_mov_b32 v50, 0
v_mov_b32 v51, 0
v_mov_b32 v52, 0
v_mov_b32 v53, 0
v_mov_b32 v54, 0
v_mov_b32 v55, 0
s_cmp_eq_u32 s52, 3
s_cselect_b32 s62, 0, -1
s_mov_b32 exec_hi, s62
L_gath_23:
buffer_load_dwordx4 v[44:47], v19, s[48:51], s64 offen offset:0 sc1
buffer_load_dwordx4 v[48:51], v19, s[48:51], s65 offen offset:0 sc1
buffer_load_dwordx4 v[52:55], v19, s[48:51], s91 offen offset:0 sc1
L_gathchk_25:
s_waitcnt vmcnt(0)
v_xor_b32 v47, s53, v47
v_xor_b32 v51, s53, v51
v_xor_b32 v55, s53, v55
v_or3_b32 v47, v47, v51, v55
v_cmp_ne_u32 vcc, 0, v47
s_nop 1
s_cbranch_vccz L_gathok_24
s_mov_b64 exec, vcc
s_sub_u32 s54, s54, 1
s_cmp_gt_i32 s54, 0
s_cbranch_scc1 L_gath_23
L_gathok_24:
s_mov_b64 exec, -1
v_lshlrev_b32 v32, 16, v44
v_lshlrev_b32 v33, 16, v48
v_and_b32 v34, s66, v44
v_and_b32 v35, s66, v48
v_lshlrev_b32 v36, 16, v45
v_lshlrev_b32 v37, 16, v49
v_and_b32 v38, s66, v45
v_and_b32 v39, s66, v49
v_lshlrev_b32 v40, 16, v46
v_lshlrev_b32 v41, 16, v50
v_and_b32 v42, s66, v46
v_and_b32 v43, s66, v50
v_lshlrev_b32 v44, 16, v52
v_lshlrev_b32 v45, 16, v53
v_and_b32 v46, s66, v52
v_and_b32 v47, s66, v53
v_pk_add_f32 v[32:33], v[32:33], v[208:209]
v_pk_add_f32 v[34:35], v[34:35], v[210:211]
v_pk_add_f32 v[36:37], v[36:37], v[212:213]
v_pk_add_f32 v[38:39], v[38:39], v[214:215]
v_pk_add_f32 v[40:41], v[40:41], v[216:217]
v_pk_add_f32 v[42:43], v[42:43], v[218:219]
v_pk_add_f32 v[44:45], v[44:45], v[220:221]
v_pk_add_f32 v[46:47], v[46:47], v[222:223]
v_pk_fma_f32 v[32:33], v[192:193], v[32:33], v[176:177]
v_pk_fma_f32 v[34:35], v[194:195], v[34:35], v[178:179]
v_pk_fma_f32 v[36:37], v[196:197], v[36:37], v[180:181]
v_pk_fma_f32 v[38:39], v[198:199], v[38:39], v[182:183]
v_pk_fma_f32 v[40:41], v[200:201], v[40:41], v[184:185]
v_pk_fma_f32 v[42:43], v[202:203], v[42:43], v[186:187]
v_pk_fma_f32 v[44:45], v[204:205], v[44:45], v[188:189]
v_pk_fma_f32 v[46:47], v[206:207], v[46:47], v[190:191]
v_add_f32 v64, v32, v33
v_mul_f32 v72, v32, v32
v_fmac_f32 v72, v33, v33
v_add_f32 v65, v34, v35
v_mul_f32 v73, v34, v34
v_fmac_f32 v73, v35, v35
v_add_f32 v66, v36, v37
v_mul_f32 v74, v36, v36
v_fmac_f32 v74, v37, v37
v_add_f32 v67, v38, v39
v_mul_f32 v75, v38, v38
v_fmac_f32 v75, v39, v39
v_add_f32 v68, v40, v41
v_mul_f32 v76, v40, v40
v_fmac_f32 v76, v41, v41
v_add_f32 v69, v42, v43
v_mul_f32 v77, v42, v42
v_fmac_f32 v77, v43, v43
v_add_f32 v70, v44, v45
v_mul_f32 v78, v44, v44
v_fmac_f32 v78, v45, v45
v_add_f32 v71, v46, v47
v_mul_f32 v79, v46, v46
v_fmac_f32 v79, v47, v47
v_permlane32_swap_b32 v64, v72
v_permlane32_swap_b32 v65, v73
v_permlane32_swap_b32 v66, v74
v_permlane32_swap_b32 v67, v75
v_permlane32_swap_b32 v68, v76
v_permlane32_swap_b32 v69, v77
v_permlane32_swap_b32 v70, v78
v_permlane32_swap_b32 v71, v79
v_add_f32 v64, v64, v72
v_add_f32 v65, v65, v73
v_add_f32 v66, v66, v74
v_add_f32 v67, v67, v75
v_add_f32 v68, v68, v76
v_add_f32 v69, v69, v77
v_add_f32 v70, v70, v78
v_add_f32 v71, v71, v79
s_nop 0
v_permlane16_swap_b32 v64, v68
v_permlane16_swap_b32 v65, v69
v_permlane16_swap_b32 v66, v70
v_permlane16_swap_b32 v67, v71
v_add_f32 v64, v64, v68
v_add_f32 v65, v65, v69
v_add_f32 v66, v66, v70
v_add_f32 v67, v67, v71
v_add_f32_dpp v64, v64, v64 row_ror:8 row_mask:0xf bank_mask:0xf
v_add_f32_dpp v65, v65, v65 row_ror:8 row_mask:0xf bank_mask:0xf
v_add_f32_dpp v66, v66, v66 row_ror:8 row_mask:0xf bank_mask:0xf
v_add_f32_dpp v67, v67, v67 row_ror:8 row_mask:0xf bank_mask:0xf
v_add_f32_dpp v64, v64, v64 row_ror:4 row_mask:0xf bank_mask:0xf
v_add_f32_dpp v65, v65, v65 row_ror:4 row_mask:0xf bank_mask:0xf
v_add_f32_dpp v66, v66, v66 row_ror:4 row_mask:0xf bank_mask:0xf
v_add_f32_dpp v67, v67, v67 row_ror:4 row_mask:0xf bank_mask:0xf
v_add_f32_dpp v64, v64, v64 row_ror:2 row_mask:0xf bank_mask:0xf
v_add_f32_dpp v65, v65, v65 row_ror:2 row_mask:0xf bank_mask:0xf
v_add_f32_dpp v66, v66, v66 row_ror:2 row_mask:0xf bank_mask:0xf
v_add_f32_dpp v67, v67, v67 row_ror:2 row_mask:0xf bank_mask:0xf
v_add_f32_dpp v64, v64, v64 row_ror:1 row_mask:0xf bank_mask:0xf
v_add_f32_dpp v65, v65, v65 row_ror:1 row_mask:0xf bank_mask:0xf
v_add_f32_dpp v66, v66, v66 row_ror:1 row_mask:0xf bank_mask:0xf
v_add_f32_dpp v67, v67, v67 row_ror:1 row_mask:0xf bank_mask:0xf
s_mov_b64 s[84:85], exec
s_mov_b32 exec_lo, 0x00010001
s_mov_b32 exec_hi, 0x00010001
ds_write_b32 v224, v64 offset:256
ds_write_b32 v224, v65 offset:272
ds_write_b32 v224, v66 offset:288
ds_write_b32 v224, v67 offset:304
s_mov_b64 exec, s[84:85]
s_mov_b32 s60, 0x3b124925
s_mov_b32 s61, 0x3727c5ac
s_waitcnt lgkmcnt(0)
s_barrier
ds_read_b128 v[64:67], v225 offset:256
ds_read_b128 v[68:71], v225 offset:384
v_cvt_pk_bf16_f32 v16, v32, v33
v_cvt_pk_bf16_f32 v17, v34, v35
v_cvt_pk_bf16_f32 v18, v36, v37
v_cvt_pk_bf16_f32 v19, v38, v39
v_cvt_pk_bf16_f32 v20, v40, v41
v_cvt_pk_bf16_f32 v21, v42, v43
v_cvt_pk_bf16_f32 v22, v44, v45
v_cvt_pk_bf16_f32 v23, v46, v47
s_waitcnt lgkmcnt(0)
v_add_f32 v64, v64, v65
v_add_f32 v68, v68, v69
v_add_f32 v66, v66, v67
v_add_f32 v70, v70, v71
v_add_f32 v64, v64, v66
v_add_f32 v68, v68, v70
v_mul_f32 v64, s60, v64
v_mul_f32 v68, s60, v68
v_fma_f32 v68, -v64, v64, v68
v_max_f32 v68, 0, v68
v_add_f32 v69, s61, v68
v_rsq_f32 v69, v69
s_nop 0
v_mul_f32 v70, v69, v69
v_mul_f32 v70, v70, v68
v_add_f32 v70, s61, v70
v_rsq_f32 v70, v70
s_nop 0
v_mul_f32 v69, v69, v70
s_nop 1
v_readlane_b32 s68, v64, 0
v_readlane_b32 s69, v69, 0
v_readlane_b32 s70, v64, 1
v_readlane_b32 s71, v69, 1
v_readlane_b32 s72, v64, 2
v_readlane_b32 s73, v69, 2
v_readlane_b32 s74, v64, 3
v_readlane_b32 s75, v69, 3
v_readlane_b32 s76, v64, 4
v_readlane_b32 s77, v69, 4
v_readlane_b32 s78, v64, 5
v_readlane_b32 s79, v69, 5
v_readlane_b32 s80, v64, 6
v_readlane_b32 s81, v69, 6
v_readlane_b32 s82, v64, 7
v_readlane_b32 s83, v69, 7
s_nop 1
v_pk_add_f32 v[32:33], v[32:33], s[68:69] op_sel:[0,0] op_sel_hi:[1,0] neg_lo:[0,1] neg_hi:[0,1]
v_pk_mul_f32 v[32:33], v[32:33], s[68:69] op_sel:[0,1] op_sel_hi:[1,1]
v_pk_add_f32 v[34:35], v[34:35], s[70:71] op_sel:[0,0] op_sel_hi:[1,0] neg_lo:[0,1] neg_hi:[0,1]
v_pk_mul_f32 v[34:35], v[34:35], s[70:71] op_sel:[0,1] op_sel_hi:[1,1]
v_pk_add_f32 v[36:37], v[36:37], s[72:73] op_sel:[0,0] op_sel_hi:[1,0] neg_lo:[0,1] neg_hi:[0,1]
v_pk_mul_f32 v[36:37], v[36:37], s[72:73] op_sel:[0,1] op_sel_hi:[1,1]
v_pk_add_f32 v[38:39], v[38:39], s[74:75] op_sel:[0,0] op_sel_hi:[1,0] neg_lo:[0,1] neg_hi:[0,1]
v_pk_mul_f32 v[38:39], v[38:39], s[74:75] op_sel:[0,1] op_sel_hi:[1,1]
v_pk_add_f32 v[40:41], v[40:41], s[76:77] op_sel:[0,0] op_sel_hi:[1,0] neg_lo:[0,1] neg_hi:[0,1]
v_pk_mul_f32 v[40:41], v[40:41], s[76:77] op_sel:[0,1] op_sel_hi:[1,1]
v_pk_add_f32 v[42:43], v[42:43], s[78:79] op_sel:[0,0] op_sel_hi:[1,0] neg_lo:[0,1] neg_hi:[0,1]
v_pk_mul_f32 v[42:43], v[42:43], s[78:79] op_sel:[0,1] op_sel_hi:[1,1]
v_pk_add_f32 v[44:45], v[44:45], s[80:81] op_sel:[0,0] op_sel_hi:[1,0] neg_lo:[0,1] neg_hi:[0,1]
v_pk_mul_f32 v[44:45], v[44:45], s[80:81] op_sel:[0,1] op_sel_hi:[1,1]
v_pk_add_f32 v[46:47], v[46:47], s[82:83] op_sel:[0,0] op_sel_hi:[1,0] neg_lo:[0,1] neg_hi:[0,1]
v_pk_mul_f32 v[46:47], v[46:47], s[82:83] op_sel:[0,1] op_sel_hi:[1,1]
v_cvt_pk_bf16_f32 v8, v32, v34
v_cvt_pk_bf16_f32 v9, v36, v38
v_cvt_pk_bf16_f32 v10, v40, v42
v_cvt_pk_bf16_f32 v11, v44, v46
v_cvt_pk_bf16_f32 v12, v33, v35
v_cvt_pk_bf16_f32 v13, v37, v39
v_cvt_pk_bf16_f32 v14, v41, v43
v_cvt_pk_bf16_f32 v15, v45, v47
s_mov_b32 s62, 7340032
s_mov_b32 s63, 7471104
buffer_store_dwordx4 v[8:11], v27, s[48:51], s62 offen sc1
buffer_store_dwordx4 v[12:15], v27, s[48:51], s63 offen sc1
s_mov_b32 s63, 9437184
buffer_store_dwordx4 v[16:19], v29, s[48:51], s63 offen sc1
buffer_store_dwordx4 v[20:23], v29, s[48:51], s63 offen offset:3584 sc1
s_waitcnt vmcnt(0)
s_lshl_b32 s60, s67, 2
s_add_u32 s60, s60, s52
s_mul_i32 s60, s60, 64
s_add_u32 s60, s60, 131072
v_mov_b32 v2, s60
v_mov_b32 v3, s53
s_mov_b64 s[84:85], exec
s_mov_b64 exec, 1
buffer_store_dword v3, v2, s[48:51], 0 offen sc1
s_mov_b64 exec, s[84:85]
s_cmp_lt_u32 s56, 28
s_cbranch_scc1 L_nopf_26
s_lshl_b32 s61, s55, 9
s_sub_u32 s60, s56, 28
s_mul_i32 s60, s60, 448
s_mul_i32 s62, s52, 84
s_add_u32 s60, s60, s62
s_add_u32 s60, s60, 112
s_mul_i32 s60, s60, 4096
s_add_u32 s60, s60, s61
v_lshrrev_b32 v2, 5, v1
v_mul_u32_u24 v2, 4096, v2
v_and_b32 v3, 31, v1
v_lshl_add_u32 v2, v3, 4, v2
v_add_u32 v2, s60, v2
s_mov_b32 s92, 0
buffer_load_dwordx4 a[0:3], v2, s[36:39], s92 offen
s_mov_b32 s92, 8192
buffer_load_dwordx4 a[4:7], v2, s[36:39], s92 offen
s_mov_b32 s92, 16384
buffer_load_dwordx4 a[8:11], v2, s[36:39], s92 offen
s_mov_b32 s92, 24576
buffer_load_dwordx4 a[12:15], v2, s[36:39], s92 offen
s_mov_b32 s92, 32768
buffer_load_dwordx4 a[16:19], v2, s[36:39], s92 offen
s_mov_b32 s92, 40960
buffer_load_dwordx4 a[20:23], v2, s[36:39], s92 offen
s_mov_b32 s92, 49152
buffer_load_dwordx4 a[24:27], v2, s[36:39], s92 offen
s_mov_b32 s92, 57344
buffer_load_dwordx4 a[28:31], v2, s[36:39], s92 offen
s_mov_b32 s92, 65536
buffer_load_dwordx4 a[32:35], v2, s[36:39], s92 offen
s_mov_b32 s92, 73728
buffer_load_dwordx4 a[36:39], v2, s[36:39], s92 offen
s_mov_b32 s92, 81920
buffer_load_dwordx4 a[40:43], v2, s[36:39], s92 offen
s_mov_b32 s92, 90112
buffer_load_dwordx4 a[44:47], v2, s[36:39], s92 offen
s_mov_b32 s92, 98304
buffer_load_dwordx4 a[48:51], v2, s[36:39], s92 offen
s_mov_b32 s92, 106496
buffer_load_dwordx4 a[52:55], v2, s[36:39], s92 offen
s_mov_b32 s92, 114688
buffer_load_dwordx4 a[56:59], v2, s[36:39], s92 offen
s_mov_b32 s92, 122880
buffer_load_dwordx4 a[60:63], v2, s[36:39], s92 offen
s_mov_b32 s92, 131072
buffer_load_dwordx4 a[0:3], v2, s[36:39], s92 offen
s_mov_b32 s92, 139264
buffer_load_dwordx4 a[4:7], v2, s[36:39], s92 offen
s_mov_b32 s92, 147456
buffer_load_dwordx4 a[8:11], v2, s[36:39], s92 offen
s_mov_b32 s92, 155648
buffer_load_dwordx4 a[12:15], v2, s[36:39], s92 offen
s_mov_b32 s92, 163840
buffer_load_dwordx4 a[16:19], v2, s[36:39], s92 offen
s_mov_b32 s92, 172032
buffer_load_dwordx4 a[20:23], v2, s[36:39], s92 offen
s_mov_b32 s92, 180224
buffer_load_dwordx4 a[24:27], v2, s[36:39], s92 offen
s_mov_b32 s92, 188416
buffer_load_dwordx4 a[28:31], v2, s[36:39], s92 offen
s_mov_b32 s92, 196608
buffer_load_dwordx4 a[32:35], v2, s[36:39], s92 offen
s_mov_b32 s92, 204800
buffer_load_dwordx4 a[36:39], v2, s[36:39], s92 offen
s_mov_b32 s92, 212992
buffer_load_dwordx4 a[40:43], v2, s[36:39], s92 offen
s_mov_b32 s92, 221184
buffer_load_dwordx4 a[44:47], v2, s[36:39], s92 offen
s_mov_b32 s92, 229376
buffer_load_dwordx4 a[48:51], v2, s[36:39], s92 offen
s_mov_b32 s92, 237568
buffer_load_dwordx4 a[52:55], v2, s[36:39], s92 offen
s_mov_b32 s92, 245760
buffer_load_dwordx4 a[56:59], v2, s[36:39], s92 offen
s_mov_b32 s92, 253952
buffer_load_dwordx4 a[60:63], v2, s[36:39], s92 offen
s_mov_b32 s92, 262144
buffer_load_dwordx4 a[0:3], v2, s[36:39], s92 offen
s_mov_b32 s92, 270336
buffer_load_dwordx4 a[4:7], v2, s[36:39], s92 offen
s_mov_b32 s92, 278528
buffer_load_dwordx4 a[8:11], v2, s[36:39], s92 offen
s_mov_b32 s92, 286720
buffer_load_dwordx4 a[12:15], v2, s[36:39], s92 offen
s_mov_b32 s92, 294912
buffer_load_dwordx4 a[16:19], v2, s[36:39], s92 offen
s_mov_b32 s92, 303104
buffer_load_dwordx4 a[20:23], v2, s[36:39], s92 offen
s_mov_b32 s92, 311296
buffer_load_dwordx4 a[24:27], v2, s[36:39], s92 offen
s_mov_b32 s92, 319488
buffer_load_dwordx4 a[28:31], v2, s[36:39], s92 offen
s_mov_b32 s92, 327680
buffer_load_dwordx4 a[32:35], v2, s[36:39], s92 offen
s_mov_b32 s92, 335872
buffer_load_dwordx4 a[36:39], v2, s[36:39], s92 offen
L_nopf_26:
L_convend_5:
s_cmp_eq_u32 s94, 0
s_cbranch_scc1 L_nogemm_27
s_lshl_b32 s60, s52, 6
v_add_u32 v2, s60, v1
v_mul_u32_u24 v2, 256, v2
s_lshr_b32 s60, s58, 1
s_mul_i32 s60, s60, 64
s_add_u32 s60, s60, 131072
v_add_u32 v2, s60, v2
s_add_u32 s95, s96, 0
s_mov_b32 m0, s95
s_mov_b32 s92, 1376256
buffer_load_dwordx4 v26, s[28:31], s92 offen offset:0 lds
s_mov_b32 s92, 1403904
buffer_load_dwordx4 v26, s[28:31], s92 offen offset:1024 lds
s_mov_b32 s92, 1431552
buffer_load_dwordx4 v26, s[28:31], s92 offen offset:2048 lds
v_and_b32 v6, 31, v1
v_lshrrev_b32 v7, 5, v1
v_lshlrev_b32 v3, 4, v1
s_mul_i32 s60, s52, 32768
s_mul_i32 s61, s58, 262144
s_add_u32 s60, s60, s61
s_add_u32 s60, s60, 7340032
v_add_u32 v3, s60, v3
s_mov_b32 s92, 1459200
buffer_load_dwordx4 v26, s[28:31], s92 offen offset:3072 lds
s_add_u32 s95, s96, 4096
s_mov_b32 m0, s95
s_mov_b32 s92, 1490944
buffer_load_dwordx4 v26, s[28:31], s92 offen offset:0 lds
s_mov_b32 s92, 1518592
buffer_load_dwordx4 v26, s[28:31], s92 offen offset:1024 lds
s_lshr_b32 s62, s52, 1
s_and_b32 s63, s52, 1
s_lshl_b32 s60, s59, 6
s_lshl_b32 s61, s62, 5
s_add_u32 s60, s60, s61
s_lshl_b32 s61, s63, 4
s_add_u32 s60, s60, s61
s_lshl_b32 s60, s60, 1
v_lshlrev_b32 v4, 3, v7
v_add_u32 v4, s60, v4
buffer_load_dwordx2 v[10:11], v4, s[32:35], 0 offen
buffer_load_dwordx2 v[12:13], v4, s[32:35], 0 offen offset:16
s_mov_b32 s92, 1546240
buffer_load_dwordx4 v26, s[28:31], s92 offen offset:2048 lds
s_mov_b32 s92, 1573888
buffer_load_dwordx4 v26, s[28:31], s92 offen offset:3072 lds
s_add_u32 s95, s96, 8192
s_mov_b32 m0, s95
s_mov_b32 s92, 1605632
buffer_load_dwordx4 v26, s[28:31], s92 offen offset:0 lds
s_lshl_b32 s60, s59, 3
s_lshl_b32 s61, s62, 2
s_add_u32 s60, s60, s61
s_lshl_b32 s61, s63, 1
s_add_u32 s60, s60, s61
s_lshl_b32 s60, s60, 9
s_mul_i32 s61, s58, 229376
s_add_u32 s60, s60, s61
s_add_u32 s60, s60, 11534336
v_lshlrev_b32 v14, 4, v1
v_add_u32 v14, s60, v14
s_mov_b32 s64, 114688
s_mov_b32 s92, 1633280
buffer_load_dwordx4 v26, s[28:31], s92 offen offset:1024 lds
s_mov_b32 s92, 1660928
buffer_load_dwordx4 v26, s[28:31], s92 offen offset:2048 lds
s_mov_b32 s92, 1688576
buffer_load_dwordx4 v26, s[28:31], s92 offen offset:3072 lds
v_lshlrev_b32 v4, 4, v1
v_add_u32 v4, 131072, v4
v_mov_b32 v29, v4
s_lshl_b32 s60, s52, 11
v_add_u32 v5, s60, v4
s_lshl_b32 s60, s52, 13
v_add_u32 v4, s60, v4
s_add_u32 s95, s96, 12288
s_mov_b32 m0, s95
s_mov_b32 s92, 1720320
buffer_load_dwordx4 v26, s[28:31], s92 offen offset:0 lds
s_mov_b32 s92, 1747968
buffer_load_dwordx4 v26, s[28:31], s92 offen offset:1024 lds
s_mov_b32 s92, 1775616
buffer_load_dwordx4 v26, s[28:31], s92 offen offset:2048 lds
s_mov_b32 s92, 1803264
buffer_load_dwordx4 v26, s[28:31], s92 offen offset:3072 lds
v_lshrrev_b32 v26, 3, v1
v_and_b32 v30, 7, v1
v_lshrrev_b32 v31, 2, v1
v_and_b32 v31, 4, v31
v_xor_b32 v30, v30, v31
v_mul_u32_u24 v26, 4096, v26
v_lshl_add_u32 v26, v30, 4, v26
s_mul_i32 s60, s52, 1835008
s_lshl_b32 s61, s93, 7
s_add_u32 s60, s60, s61
v_add_u32 v26, s60, v26
s_mul_i32 s100, s59, 7
s_add_u32 s100, s100, s58
L_poll_28:
buffer_load_dword v8, v2, s[48:51], 0 offen sc1
s_waitcnt vmcnt(0)
v_cmp_ne_u32 vcc, s53, v8
s_nop 1
s_cbranch_vccz L_pollok_29
s_mov_b64 exec, vcc
s_sub_u32 s54, s54, 1
s_cmp_gt_i32 s54, 0
s_cbranch_scc1 L_poll_28
L_pollok_29:
s_mov_b64 exec, -1
s_mov_b32 s101, 0
buffer_load_dwordx4 v[160:163], v3, s[48:51], s101 offen offset:0 sc1
buffer_load_dwordx4 v[164:167], v3, s[48:51], s101 offen offset:1024 sc1
buffer_load_dwordx4 v[168:171], v3, s[48:51], s101 offen offset:2048 sc1
buffer_load_dwordx4 v[172:175], v3, s[48:51], s101 offen offset:3072 sc1
s_mov_b32 s101, 4096
buffer_load_dwordx4 v[176:179], v3, s[48:51], s101 offen offset:0 sc1
buffer_load_dwordx4 v[180:183], v3, s[48:51], s101 offen offset:1024 sc1
buffer_load_dwordx4 v[184:187], v3, s[48:51], s101 offen offset:2048 sc1
buffer_load_dwordx4 v[188:191], v3, s[48:51], s101 offen offset:3072 sc1
s_mov_b32 s101, 8192
buffer_load_dwordx4 v[192:195], v3, s[48:51], s101 offen offset:0 sc1
buffer_load_dwordx4 v[196:199], v3, s[48:51], s101 offen offset:1024 sc1
buffer_load_dwordx4 v[200:203], v3, s[48:51], s101 offen offset:2048 sc1
ds_read_b64_tr_b16 a[128:129], v24 offset:16384
ds_read_b64_tr_b16 a[130:131], v24 offset:16896
ds_read_b64_tr_b16 a[132:133], v25 offset:16384
ds_read_b64_tr_b16 a[134:135], v25 offset:16896
ds_read_b64_tr_b16 a[136:137], v24 offset:18432
ds_read_b64_tr_b16 a[138:139], v24 offset:18944
ds_read_b64_tr_b16 a[140:141], v25 offset:18432
ds_read_b64_tr_b16 a[142:143], v25 offset:18944
ds_read_b64_tr_b16 a[144:145], v24 offset:20480
ds_read_b64_tr_b16 a[146:147], v24 offset:20992
ds_read_b64_tr_b16 a[148:149], v25 offset:20480
ds_read_b64_tr_b16 a[150:151], v25 offset:20992
ds_read_b64_tr_b16 a[152:153], v24 offset:22528
ds_read_b64_tr_b16 a[154:155], v24 offset:23040
ds_read_b64_tr_b16 a[156:157], v25 offset:22528
ds_read_b64_tr_b16 a[158:159], v25 offset:23040
ds_read_b64_tr_b16 a[160:161], v24 offset:24576
ds_read_b64_tr_b16 a[162:163], v24 offset:25088
ds_read_b64_tr_b16 a[164:165], v25 offset:24576
ds_read_b64_tr_b16 a[166:167], v25 offset:25088
ds_read_b64_tr_b16 a[168:169], v24 offset:26624
ds_read_b64_tr_b16 a[170:171], v24 offset:27136
ds_read_b64_tr_b16 a[172:173], v25 offset:26624
ds_read_b64_tr_b16 a[174:175], v25 offset:27136
ds_read_b64_tr_b16 a[176:177], v24 offset:28672
ds_read_b64_tr_b16 a[178:179], v24 offset:29184
ds_read_b64_tr_b16 a[180:181], v25 offset:28672
ds_read_b64_tr_b16 a[182:183], v25 offset:29184
ds_read_b64_tr_b16 a[184:185], v24 offset:30720
ds_read_b64_tr_b16 a[186:187], v24 offset:31232
ds_read_b64_tr_b16 a[188:189], v25 offset:30720
ds_read_b64_tr_b16 a[190:191], v25 offset:31232
ds_read_b64_tr_b16 a[192:193], v24 offset:0
ds_read_b64_tr_b16 a[194:195], v24 offset:512
ds_read_b64_tr_b16 a[196:197], v25 offset:0
ds_read_b64_tr_b16 a[198:199], v25 offset:512
ds_read_b64_tr_b16 a[200:201], v24 offset:2048
ds_read_b64_tr_b16 a[202:203], v24 offset:2560
ds_read_b64_tr_b16 a[204:205], v25 offset:2048
ds_read_b64_tr_b16 a[206:207], v25 offset:2560
ds_read_b64_tr_b16 a[208:209], v24 offset:4096
ds_read_b64_tr_b16 a[210:211], v24 offset:4608
ds_read_b64_tr_b16 a[212:213], v25 offset:4096
ds_read_b64_tr_b16 a[214:215], v25 offset:4608
ds_read_b64_tr_b16 a[216:217], v24 offset:6144
ds_read_b64_tr_b16 a[218:219], v24 offset:6656
ds_read_b64_tr_b16 a[220:221], v25 offset:6144
ds_read_b64_tr_b16 a[222:223], v25 offset:6656
ds_read_b64_tr_b16 a[224:225], v24 offset:8192
ds_read_b64_tr_b16 a[226:227], v24 offset:8704
ds_read_b64_tr_b16 a[228:229], v25 offset:8192
ds_read_b64_tr_b16 a[230:231], v25 offset:8704
ds_read_b64_tr_b16 a[232:233], v24 offset:10240
ds_read_b64_tr_b16 a[234:235], v24 offset:10752
ds_read_b64_tr_b16 a[236:237], v25 offset:10240
ds_read_b64_tr_b16 a[238:239], v25 offset:10752
ds_read_b64_tr_b16 a[240:241], v24 offset:12288
ds_read_b64_tr_b16 a[242:243], v24 offset:12800
ds_read_b64_tr_b16 a[244:245], v25 offset:12288
ds_read_b64_tr_b16 a[246:247], v25 offset:12800
ds_read_b64_tr_b16 a[248:249], v24 offset:14336
ds_read_b64_tr_b16 a[250:251], v24 offset:14848
ds_read_b64_tr_b16 a[252:253], v25 offset:14336
ds_read_b64_tr_b16 a[254:255], v25 offset:14848
v_lshlrev_b32 v16, 16, v10
v_lshlrev_b32 v20, 16, v12
v_and_b32 v17, s66, v10
v_and_b32 v21, s66, v12
v_lshlrev_b32 v18, 16, v11
v_lshlrev_b32 v22, 16, v13
v_and_b32 v19, s66, v11
v_and_b32 v23, s66, v13
s_waitcnt lgkmcnt(0)
s_waitcnt vmcnt(10)
v_mfma_f32_32x32x16_bf16 v[96:111], a[0:3], v[160:163], 0
v_mfma_f32_32x32x16_bf16 v[112:127], a[4:7], v[160:163], 0
buffer_load_dwordx4 v[160:163], v3, s[48:51], s101 offen offset:3072 sc1
s_waitcnt vmcnt(10)
v_mfma_f32_32x32x16_bf16 v[96:111], a[8:11], v[164:167], v[96:111]
v_mfma_f32_32x32x16_bf16 v[112:127], a[12:15], v[164:167], v[112:127]
s_mov_b32 s101, 12288
buffer_load_dwordx4 v[164:167], v3, s[48:51], s101 offen offset:0 sc1
s_waitcnt vmcnt(10)
v_mfma_f32_32x32x16_bf16 v[96:111], a[16:19], v[168:171], v[96:111]
v_mfma_f32_32x32x16_bf16 v[112:127], a[20:23], v[168:171], v[112:127]
buffer_load_dwordx4 v[168:171], v3, s[48:51], s101 offen offset:1024 sc1
s_waitcnt vmcnt(10)
v_mfma_f32_32x32x16_bf16 v[96:111], a[24:27], v[172:175], v[96:111]
v_mfma_f32_32x32x16_bf16 v[112:127], a[28:31], v[172:175], v[112:127]
buffer_load_dwordx4 v[172:175], v3, s[48:51], s101 offen offset:2048 sc1
s_waitcnt vmcnt(10)
v_mfma_f32_32x32x16_bf16 v[96:111], a[32:35], v[176:179], v[96:111]
v_mfma_f32_32x32x16_bf16 v[112:127], a[36:39], v[176:179], v[112:127]
buffer_load_dwordx4 v[176:179], v3, s[48:51], s101 offen offset:3072 sc1
s_waitcnt vmcnt(10)
v_mfma_f32_32x32x16_bf16 v[96:111], a[40:43], v[180:183], v[96:111]
v_mfma_f32_32x32x16_bf16 v[112:127], a[44:47], v[180:183], v[112:127]
s_mov_b32 s101, 16384
buffer_load_dwordx4 v[180:183], v3, s[48:51], s101 offen offset:0 sc1
s_waitcnt vmcnt(10)
v_mfma_f32_32x32x16_bf16 v[96:111], a[48:51], v[184:187], v[96:111]
v_mfma_f32_32x32x16_bf16 v[112:127], a[52:55], v[184:187], v[112:127]
buffer_load_dwordx4 v[184:187], v3, s[48:51], s101 offen offset:1024 sc1
s_waitcnt vmcnt(10)
v_mfma_f32_32x32x16_bf16 v[96:111], a[56:59], v[188:191], v[96:111]
v_mfma_f32_32x32x16_bf16 v[112:127], a[60:63], v[188:191], v[112:127]
buffer_load_dwordx4 v[188:191], v3, s[48:51], s101 offen offset:2048 sc1
s_waitcnt vmcnt(10)
v_mfma_f32_32x32x16_bf16 v[96:111], a[64:67], v[192:195], v[96:111]
v_mfma_f32_32x32x16_bf16 v[112:127], a[68:71], v[192:195], v[112:127]
buffer_load_dwordx4 v[192:195], v3, s[48:51], s101 offen offset:3072 sc1
s_waitcnt vmcnt(10)
v_mfma_f32_32x32x16_bf16 v[96:111], a[72:75], v[196:199], v[96:111]
v_mfma_f32_32x32x16_bf16 v[112:127], a[76:79], v[196:199], v[112:127]
s_mov_b32 s101, 20480
buffer_load_dwordx4 v[196:199], v3, s[48:51], s101 offen offset:0 sc1
s_waitcnt vmcnt(10)
v_mfma_f32_32x32x16_bf16 v[96:111], a[80:83], v[200:203], v[96:111]
v_mfma_f32_32x32x16_bf16 v[112:127], a[84:87], v[200:203], v[112:127]
buffer_load_dwordx4 v[200:203], v3, s[48:51], s101 offen offset:1024 sc1
s_waitcnt vmcnt(10)
v_mfma_f32_32x32x16_bf16 v[96:111], a[88:91], v[160:163], v[96:111]
v_mfma_f32_32x32x16_bf16 v[112:127], a[92:95], v[160:163], v[112:127]
buffer_load_dwordx4 v[160:163], v3, s[48:51], s101 offen offset:2048 sc1
s_waitcnt vmcnt(10)
v_mfma_f32_32x32x16_bf16 v[96:111], a[96:99], v[164:167], v[96:111]
v_mfma_f32_32x32x16_bf16 v[112:127], a[100:103], v[164:167], v[112:127]
buffer_load_dwordx4 v[164:167], v3, s[48:51], s101 offen offset:3072 sc1
s_waitcnt vmcnt(10)
v_mfma_f32_32x32x16_bf16 v[96:111], a[104:107], v[168:171], v[96:111]
v_mfma_f32_32x32x16_bf16 v[112:127], a[108:111], v[168:171], v[112:127]
s_mov_b32 s101, 24576
buffer_load_dwordx4 v[168:171], v3, s[48:51], s101 offen offset:0 sc1
s_waitcnt vmcnt(10)
v_mfma_f32_32x32x16_bf16 v[96:111], a[112:115], v[172:175], v[96:111]
v_mfma_f32_32x32x16_bf16 v[112:127], a[116:119], v[172:175], v[112:127]
buffer_load_dwordx4 v[172:175], v3, s[48:51], s101 offen offset:1024 sc1
s_waitcnt vmcnt(10)
v_mfma_f32_32x32x16_bf16 v[96:111], a[120:123], v[176:179], v[96:111]
v_mfma_f32_32x32x16_bf16 v[112:127], a[124:127], v[176:179], v[112:127]
buffer_load_dwordx4 v[176:179], v3, s[48:51], s101 offen offset:2048 sc1
s_waitcnt vmcnt(10)
v_mfma_f32_32x32x16_bf16 v[96:111], a[128:131], v[180:183], v[96:111]
v_mfma_f32_32x32x16_bf16 v[112:127], a[132:135], v[180:183], v[112:127]
buffer_load_dwordx4 v[180:183], v3, s[48:51], s101 offen offset:3072 sc1
s_waitcnt vmcnt(10)
v_mfma_f32_32x32x16_bf16 v[96:111], a[136:139], v[184:187], v[96:111]
v_mfma_f32_32x32x16_bf16 v[112:127], a[140:143], v[184:187], v[112:127]
s_mov_b32 s101, 28672
buffer_load_dwordx4 v[184:187], v3, s[48:51], s101 offen offset:0 sc1
s_waitcnt vmcnt(10)
v_mfma_f32_32x32x16_bf16 v[96:111], a[144:147], v[188:191], v[96:111]
v_mfma_f32_32x32x16_bf16 v[112:127], a[148:151], v[188:191], v[112:127]
buffer_load_dwordx4 v[188:191], v3, s[48:51], s101 offen offset:1024 sc1
s_waitcnt vmcnt(10)
v_mfma_f32_32x32x16_bf16 v[96:111], a[152:155], v[192:195], v[96:111]
v_mfma_f32_32x32x16_bf16 v[112:127], a[156:159], v[192:195], v[112:127]
buffer_load_dwordx4 v[192:195], v3, s[48:51], s101 offen offset:2048 sc1
s_waitcnt vmcnt(10)
v_mfma_f32_32x32x16_bf16 v[96:111], a[160:163], v[196:199], v[96:111]
v_mfma_f32_32x32x16_bf16 v[112:127], a[164:167], v[196:199], v[112:127]
buffer_load_dwordx4 v[196:199], v3, s[48:51], s101 offen offset:3072 sc1
s_waitcnt vmcnt(10)
v_mfma_f32_32x32x16_bf16 v[96:111], a[168:171], v[200:203], v[96:111]
v_mfma_f32_32x32x16_bf16 v[112:127], a[172:175], v[200:203], v[112:127]
s_mov_b32 s101, 131072
buffer_load_dwordx4 v[200:203], v3, s[48:51], s101 offen offset:0 sc1
s_waitcnt vmcnt(10)
v_mfma_f32_32x32x16_bf16 v[96:111], a[176:179], v[160:163], v[96:111]
v_mfma_f32_32x32x16_bf16 v[112:127], a[180:183], v[160:163], v[112:127]
buffer_load_dwordx4 v[160:163], v3, s[48:51], s101 offen offset:1024 sc1
s_waitcnt vmcnt(10)
v_mfma_f32_32x32x16_bf16 v[96:111], a[184:187], v[164:167], v[96:111]
v_mfma_f32_32x32x16_bf16 v[112:127], a[188:191], v[164:167], v[112:127]
buffer_load_dwordx4 v[164:167], v3, s[48:51], s101 offen offset:2048 sc1
s_waitcnt vmcnt(10)
v_mfma_f32_32x32x16_bf16 v[96:111], a[192:195], v[168:171], v[96:111]
v_mfma_f32_32x32x16_bf16 v[112:127], a[196:199], v[168:171], v[112:127]
buffer_load_dwordx4 v[168:171], v3, s[48:51], s101 offen offset:3072 sc1
s_waitcnt vmcnt(10)
v_mfma_f32_32x32x16_bf16 v[96:111], a[200:203], v[172:175], v[96:111]
v_mfma_f32_32x32x16_bf16 v[112:127], a[204:207], v[172:175], v[112:127]
s_mov_b32 s101, 135168
buffer_load_dwordx4 v[172:175], v3, s[48:51], s101 offen offset:0 sc1
s_waitcnt vmcnt(10)
v_mfma_f32_32x32x16_bf16 v[96:111], a[208:211], v[176:179], v[96:111]
v_mfma_f32_32x32x16_bf16 v[112:127], a[212:215], v[176:179], v[112:127]
buffer_load_dwordx4 v[176:179], v3, s[48:51], s101 offen offset:1024 sc1
s_waitcnt vmcnt(10)
v_mfma_f32_32x32x16_bf16 v[96:111], a[216:219], v[180:183], v[96:111]
v_mfma_f32_32x32x16_bf16 v[112:127], a[220:223], v[180:183], v[112:127]
buffer_load_dwordx4 v[180:183], v3, s[48:51], s101 offen offset:2048 sc1
s_waitcnt vmcnt(10)
v_mfma_f32_32x32x16_bf16 v[96:111], a[224:227], v[184:187], v[96:111]
v_mfma_f32_32x32x16_bf16 v[112:127], a[228:231], v[184:187], v[112:127]
buffer_load_dwordx4 v[184:187], v3, s[48:51], s101 offen offset:3072 sc1
s_waitcnt vmcnt(10)
v_mfma_f32_32x32x16_bf16 v[96:111], a[232:235], v[188:191], v[96:111]
v_mfma_f32_32x32x16_bf16 v[112:127], a[236:239], v[188:191], v[112:127]
s_mov_b32 s101, 139264
buffer_load_dwordx4 v[188:191], v3, s[48:51], s101 offen offset:0 sc1
s_waitcnt vmcnt(10)
v_mfma_f32_32x32x16_bf16 v[96:111], a[240:243], v[192:195], v[96:111]
v_mfma_f32_32x32x16_bf16 v[112:127], a[244:247], v[192:195], v[112:127]
buffer_load_dwordx4 v[192:195], v3, s[48:51], s101 offen offset:1024 sc1
s_waitcnt vmcnt(10)
v_mfma_f32_32x32x16_bf16 v[96:111], a[248:251], v[196:199], v[96:111]
v_mfma_f32_32x32x16_bf16 v[112:127], a[252:255], v[196:199], v[112:127]
buffer_load_dwordx4 v[196:199], v3, s[48:51], s101 offen offset:2048 sc1
s_waitcnt vmcnt(10)
v_mfma_f32_32x32x16_bf16 v[128:143], a[0:3], v[200:203], 0
v_mfma_f32_32x32x16_bf16 v[144:159], a[4:7], v[200:203], 0
buffer_load_dwordx4 v[200:203], v3, s[48:51], s101 offen offset:3072 sc1
s_waitcnt vmcnt(10)
v_mfma_f32_32x32x16_bf16 v[128:143], a[8:11], v[160:163], v[128:143]
v_mfma_f32_32x32x16_bf16 v[144:159], a[12:15], v[160:163], v[144:159]
s_mov_b32 s101, 143360
buffer_load_dwordx4 v[160:163], v3, s[48:51], s101 offen offset:0 sc1
s_waitcnt vmcnt(10)
v_mfma_f32_32x32x16_bf16 v[128:143], a[16:19], v[164:167], v[128:143]
s_barrier
v_mfma_f32_32x32x16_bf16 v[144:159], a[20:23], v[164:167], v[144:159]
buffer_load_dwordx4 v[164:167], v3, s[48:51], s101 offen offset:1024 sc1
ds_write_b128 v5, v[96:99] offset:0
s_waitcnt vmcnt(10)
v_mfma_f32_32x32x16_bf16 v[128:143], a[24:27], v[168:171], v[128:143]
ds_write_b128 v5, v[100:103] offset:1024
v_mfma_f32_32x32x16_bf16 v[144:159], a[28:31], v[168:171], v[144:159]
buffer_load_dwordx4 v[168:171], v3, s[48:51], s101 offen offset:2048 sc1
ds_write_b128 v5, v[104:107] offset:8192
s_waitcnt vmcnt(10)
v_mfma_f32_32x32x16_bf16 v[128:143], a[32:35], v[172:175], v[128:143]
ds_write_b128 v5, v[108:111] offset:9216
v_mfma_f32_32x32x16_bf16 v[144:159], a[36:39], v[172:175], v[144:159]
buffer_load_dwordx4 v[172:175], v3, s[48:51], s101 offen offset:3072 sc1
ds_write_b128 v5, v[112:115] offset:16384
s_waitcnt vmcnt(10)
v_mfma_f32_32x32x16_bf16 v[128:143], a[40:43], v[176:179], v[128:143]
ds_write_b128 v5, v[116:119] offset:17408
v_mfma_f32_32x32x16_bf16 v[144:159], a[44:47], v[176:179], v[144:159]
s_mov_b32 s101, 147456
buffer_load_dwordx4 v[176:179], v3, s[48:51], s101 offen offset:0 sc1
ds_write_b128 v5, v[120:123] offset:24576
s_waitcnt vmcnt(10)
v_mfma_f32_32x32x16_bf16 v[128:143], a[48:51], v[180:183], v[128:143]
ds_write_b128 v5, v[124:127] offset:25600
v_mfma_f32_32x32x16_bf16 v[144:159], a[52:55], v[180:183], v[144:159]
buffer_load_dwordx4 v[180:183], v3, s[48:51], s101 offen offset:1024 sc1
s_waitcnt lgkmcnt(0)
s_barrier
ds_read_b128 v[32:35], v4 offset:0
s_waitcnt vmcnt(10)
v_mfma_f32_32x32x16_bf16 v[128:143], a[56:59], v[184:187], v[128:143]
ds_read_b128 v[36:39], v4 offset:1024
ds_read_b128 v[40:43], v4 offset:2048
ds_read_b128 v[44:47], v4 offset:3072
v_mfma_f32_32x32x16_bf16 v[144:159], a[60:63], v[184:187], v[144:159]
buffer_load_dwordx4 v[184:187], v3, s[48:51], s101 offen offset:2048 sc1
ds_read_b128 v[48:51], v4 offset:4096
ds_read_b128 v[52:55], v4 offset:5120
ds_read_b128 v[56:59], v4 offset:6144
s_waitcnt vmcnt(10)
v_mfma_f32_32x32x16_bf16 v[128:143], a[64:67], v[188:191], v[128:143]
ds_read_b128 v[60:63], v4 offset:7168
s_waitcnt lgkmcnt(0)
v_add_f32 v32, v32, v40
v_mfma_f32_32x32x16_bf16 v[144:159], a[68:71], v[188:191], v[144:159]
buffer_load_dwordx4 v[188:191], v3, s[48:51], s101 offen offset:3072 sc1
v_add_f32 v33, v33, v41
v_add_f32 v48, v48, v56
v_add_f32 v49, v49, v57
s_waitcnt vmcnt(10)
v_mfma_f32_32x32x16_bf16 v[128:143], a[72:75], v[192:195], v[128:143]
v_add_f32 v34, v34, v42
v_add_f32 v35, v35, v43
v_add_f32 v50, v50, v58
v_mfma_f32_32x32x16_bf16 v[144:159], a[76:79], v[192:195], v[144:159]
s_mov_b32 s101, 151552
buffer_load_dwordx4 v[192:195], v3, s[48:51], s101 offen offset:0 sc1
v_add_f32 v51, v51, v59
v_add_f32 v36, v36, v44
v_add_f32 v37, v37, v45
s_waitcnt vmcnt(10)
v_mfma_f32_32x32x16_bf16 v[128:143], a[80:83], v[196:199], v[128:143]
v_add_f32 v52, v52, v60
v_add_f32 v53, v53, v61
v_add_f32 v38, v38, v46
v_mfma_f32_32x32x16_bf16 v[144:159], a[84:87], v[196:199], v[144:159]
buffer_load_dwordx4 v[196:199], v3, s[48:51], s101 offen offset:1024 sc1
v_add_f32 v39, v39, v47
v_add_f32 v54, v54, v62
v_add_f32 v55, v55, v63
s_waitcnt vmcnt(10)
v_mfma_f32_32x32x16_bf16 v[128:143], a[88:91], v[200:203], v[128:143]
v_add_f32 v32, v32, v48
v_add_f32 v33, v33, v49
v_add_f32 v34, v34, v50
v_mfma_f32_32x32x16_bf16 v[144:159], a[92:95], v[200:203], v[144:159]
buffer_load_dwordx4 v[200:203], v3, s[48:51], s101 offen offset:2048 sc1
v_add_f32 v35, v35, v51
v_add_f32 v36, v36, v52
v_add_f32 v37, v37, v53
s_waitcnt vmcnt(10)
v_mfma_f32_32x32x16_bf16 v[128:143], a[96:99], v[160:163], v[128:143]
v_add_f32 v38, v38, v54
v_add_f32 v39, v39, v55
v_add_f32 v32, v32, v16
v_mfma_f32_32x32x16_bf16 v[144:159], a[100:103], v[160:163], v[144:159]
buffer_load_dwordx4 v[160:163], v3, s[48:51], s101 offen offset:3072 sc1
v_add_f32 v33, v33, v17
v_add_f32 v34, v34, v18
v_add_f32 v35, v35, v19
s_waitcnt vmcnt(10)
v_mfma_f32_32x32x16_bf16 v[128:143], a[104:107], v[164:167], v[128:143]
v_add_f32 v36, v36, v20
v_add_f32 v37, v37, v21
v_add_f32 v38, v38, v22
v_mfma_f32_32x32x16_bf16 v[144:159], a[108:111], v[164:167], v[144:159]
s_mov_b32 s101, 155648
buffer_load_dwordx4 v[164:167], v3, s[48:51], s101 offen offset:0 sc1
v_add_f32 v39, v39, v23
s_mov_b32 s90, 0xc0135761
s_mov_b32 s91, 0xbdd2d3e8
s_waitcnt vmcnt(10)
v_mfma_f32_32x32x16_bf16 v[128:143], a[112:115], v[168:171], v[128:143]
v_mov_b32 v48, s90
v_mul_f32 v40, v32, v32
v_mul_f32 v41, v33, v33
v_mfma_f32_32x32x16_bf16 v[144:159], a[116:119], v[168:171], v[144:159]
buffer_load_dwordx4 v[168:171], v3, s[48:51], s101 offen offset:1024 sc1
v_mul_f32 v42, v34, v34
v_mul_f32 v43, v35, v35
v_mul_f32 v44, v36, v36
s_waitcnt vmcnt(10)
v_mfma_f32_32x32x16_bf16 v[128:143], a[120:123], v[172:175], v[128:143]
v_mul_f32 v45, v37, v37
v_mul_f32 v46, v38, v38
v_mul_f32 v47, v39, v39
v_mfma_f32_32x32x16_bf16 v[144:159], a[124:127], v[172:175], v[144:159]
buffer_load_dwordx4 v[172:175], v3, s[48:51], s101 offen offset:2048 sc1
v_fma_f32 v40, v40, s91, v48
v_fma_f32 v41, v41, s91, v48
v_fma_f32 v42, v42, s91, v48
s_waitcnt vmcnt(10)
v_mfma_f32_32x32x16_bf16 v[128:143], a[128:131], v[176:179], v[128:143]
v_fma_f32 v43, v43, s91, v48
v_fma_f32 v44, v44, s91, v48
v_fma_f32 v45, v45, s91, v48
v_mfma_f32_32x32x16_bf16 v[144:159], a[132:135], v[176:179], v[144:159]
buffer_load_dwordx4 v[176:179], v3, s[48:51], s101 offen offset:3072 sc1
v_fma_f32 v46, v46, s91, v48
v_fma_f32 v47, v47, s91, v48
v_mul_f32 v40, v40, v32
s_waitcnt vmcnt(10)
v_mfma_f32_32x32x16_bf16 v[128:143], a[136:139], v[180:183], v[128:143]
v_mul_f32 v41, v41, v33
v_mul_f32 v42, v42, v34
v_mul_f32 v43, v43, v35
v_mfma_f32_32x32x16_bf16 v[144:159], a[140:143], v[180:183], v[144:159]
s_mov_b32 s101, 159744
buffer_load_dwordx4 v[180:183], v3, s[48:51], s101 offen offset:0 sc1
v_mul_f32 v44, v44, v36
v_mul_f32 v45, v45, v37
v_mul_f32 v46, v46, v38
s_waitcnt vmcnt(10)
v_mfma_f32_32x32x16_bf16 v[128:143], a[144:147], v[184:187], v[128:143]
v_mul_f32 v47, v47, v39
v_exp_f32 v40, v40
v_mfma_f32_32x32x16_bf16 v[144:159], a[148:151], v[184:187], v[144:159]
buffer_load_dwordx4 v[184:187], v3, s[48:51], s101 offen offset:1024 sc1
v_exp_f32 v41, v41
s_waitcnt vmcnt(10)
v_mfma_f32_32x32x16_bf16 v[128:143], a[152:155], v[188:191], v[128:143]
v_exp_f32 v42, v42
v_mfma_f32_32x32x16_bf16 v[144:159], a[156:159], v[188:191], v[144:159]
buffer_load_dwordx4 v[188:191], v3, s[48:51], s101 offen offset:2048 sc1
v_exp_f32 v43, v43
s_waitcnt vmcnt(10)
v_mfma_f32_32x32x16_bf16 v[128:143], a[160:163], v[192:195], v[128:143]
v_exp_f32 v44, v44
v_mfma_f32_32x32x16_bf16 v[144:159], a[164:167], v[192:195], v[144:159]
buffer_load_dwordx4 v[192:195], v3, s[48:51], s101 offen offset:3072 sc1
v_exp_f32 v45, v45
s_waitcnt vmcnt(10)
v_mfma_f32_32x32x16_bf16 v[128:143], a[168:171], v[196:199], v[128:143]
v_exp_f32 v46, v46
v_mfma_f32_32x32x16_bf16 v[144:159], a[172:175], v[196:199], v[144:159]
v_exp_f32 v47, v47
v_add_f32 v40, 1.0, v40
s_add_u32 s95, s96, 0
s_mov_b32 m0, s95
s_mov_b32 s92, 0
buffer_load_dwordx4 v26, s[36:39], s92 offen offset:0 lds
s_waitcnt vmcnt(10)
v_mfma_f32_32x32x16_bf16 v[128:143], a[176:179], v[200:203], v[128:143]
v_add_f32 v41, 1.0, v41
v_add_f32 v42, 1.0, v42
v_add_f32 v43, 1.0, v43
v_mfma_f32_32x32x16_bf16 v[144:159], a[180:183], v[200:203], v[144:159]
v_add_f32 v44, 1.0, v44
v_add_f32 v45, 1.0, v45
v_add_f32 v46, 1.0, v46
s_mov_b32 s92, 31744
buffer_load_dwordx4 v26, s[36:39], s92 offen offset:1024 lds
s_waitcnt vmcnt(10)
v_mfma_f32_32x32x16_bf16 v[128:143], a[184:187], v[160:163], v[128:143]
v_add_f32 v47, 1.0, v47
v_rcp_f32 v40, v40
v_mfma_f32_32x32x16_bf16 v[144:159], a[188:191], v[160:163], v[144:159]
v_rcp_f32 v41, v41
s_mov_b32 s92, 63488
buffer_load_dwordx4 v26, s[36:39], s92 offen offset:2048 lds
s_waitcnt vmcnt(10)
v_mfma_f32_32x32x16_bf16 v[128:143], a[192:195], v[164:167], v[128:143]
v_rcp_f32 v42, v42
v_mfma_f32_32x32x16_bf16 v[144:159], a[196:199], v[164:167], v[144:159]
v_rcp_f32 v43, v43
s_mov_b32 s92, 95232
buffer_load_dwordx4 v26, s[36:39], s92 offen offset:3072 lds
s_waitcnt vmcnt(10)
v_mfma_f32_32x32x16_bf16 v[128:143], a[200:203], v[168:171], v[128:143]
v_rcp_f32 v44, v44
v_mfma_f32_32x32x16_bf16 v[144:159], a[204:207], v[168:171], v[144:159]
v_rcp_f32 v45, v45
s_add_u32 s95, s96, 4096
s_mov_b32 m0, s95
s_mov_b32 s92, 131072
buffer_load_dwordx4 v26, s[36:39], s92 offen offset:0 lds
s_waitcnt vmcnt(10)
v_mfma_f32_32x32x16_bf16 v[128:143], a[208:211], v[172:175], v[128:143]
v_rcp_f32 v46, v46
v_mfma_f32_32x32x16_bf16 v[144:159], a[212:215], v[172:175], v[144:159]
v_rcp_f32 v47, v47
s_nop 0
s_mov_b32 s92, 162816
buffer_load_dwordx4 v26, s[36:39], s92 offen offset:1024 lds
s_waitcnt vmcnt(10)
v_mfma_f32_32x32x16_bf16 v[128:143], a[216:219], v[176:179], v[128:143]
v_mul_f32 v32, v32, v40
v_mul_f32 v33, v33, v41
v_mul_f32 v34, v34, v42
v_mfma_f32_32x32x16_bf16 v[144:159], a[220:223], v[176:179], v[144:159]
v_mul_f32 v35, v35, v43
v_mul_f32 v36, v36, v44
v_mul_f32 v37, v37, v45
s_mov_b32 s92, 194560
buffer_load_dwordx4 v26, s[36:39], s92 offen offset:2048 lds
s_waitcnt vmcnt(10)
v_mfma_f32_32x32x16_bf16 v[128:143], a[224:227], v[180:183], v[128:143]
v_mul_f32 v38, v38, v46
v_mul_f32 v39, v39, v47
v_cvt_pk_bf16_f32 v48, v32, v33
v_mfma_f32_32x32x16_bf16 v[144:159], a[228:231], v[180:183], v[144:159]
v_cvt_pk_bf16_f32 v49, v34, v35
v_cvt_pk_bf16_f32 v50, v36, v37
v_cvt_pk_bf16_f32 v51, v38, v39
s_mov_b32 s92, 226304
buffer_load_dwordx4 v26, s[36:39], s92 offen offset:3072 lds
s_waitcnt vmcnt(10)
v_mfma_f32_32x32x16_bf16 v[128:143], a[232:235], v[184:187], v[128:143]
s_nop 1
v_permlane32_swap_b32 v48, v50
v_permlane32_swap_b32 v49, v51
v_mfma_f32_32x32x16_bf16 v[144:159], a[236:239], v[184:187], v[144:159]
buffer_store_dwordx4 v[48:51], v14, s[48:51], 0 offen sc1
s_add_u32 s95, s96, 8192
s_mov_b32 m0, s95
s_mov_b32 s92, 262144
buffer_load_dwordx4 v26, s[36:39], s92 offen offset:0 lds
s_waitcnt vmcnt(11)
v_mfma_f32_32x32x16_bf16 v[128:143], a[240:243], v[188:191], v[128:143]
v_mfma_f32_32x32x16_bf16 v[144:159], a[244:247], v[188:191], v[144:159]
s_mov_b32 s92, 293888
buffer_load_dwordx4 v26, s[36:39], s92 offen offset:1024 lds
s_waitcnt vmcnt(11)
v_mfma_f32_32x32x16_bf16 v[128:143], a[248:251], v[192:195], v[128:143]
v_mfma_f32_32x32x16_bf16 v[144:159], a[252:255], v[192:195], v[144:159]
s_mov_b32 s92, 325632
buffer_load_dwordx4 v26, s[36:39], s92 offen offset:2048 lds
s_nop 11
s_barrier
s_cmp_eq_u32 s52, 0
s_cbranch_scc1 L_w_30
s_cmp_eq_u32 s52, 1
s_cbranch_scc1 L_w_31
s_cmp_eq_u32 s52, 2
s_cbranch_scc1 L_w_32
ds_write_b128 v29, v[128:131] offset:4096
ds_write_b128 v29, v[132:135] offset:5120
ds_write_b128 v29, v[136:139] offset:10240
ds_write_b128 v29, v[140:143] offset:11264
ds_write_b128 v29, v[144:147] offset:16384
ds_write_b128 v29, v[148:151] offset:17408
s_branch L_wj_33
L_w_30:
ds_write_b128 v29, v[136:139] offset:12288
ds_write_b128 v29, v[140:143] offset:13312
ds_write_b128 v29, v[144:147] offset:18432
ds_write_b128 v29, v[148:151] offset:19456
ds_write_b128 v29, v[152:155] offset:24576
ds_write_b128 v29, v[156:159] offset:25600
s_branch L_wj_33
L_w_31:
ds_write_b128 v29, v[128:131] offset:0
ds_write_b128 v29, v[132:135] offset:1024
ds_write_b128 v29, v[144:147] offset:20480
ds_write_b128 v29, v[148:151] offset:21504
ds_write_b128 v29, v[152:155] offset:26624
ds_write_b128 v29, v[156:159] offset:27648
s_branch L_wj_33
L_w_32:
ds_write_b128 v29, v[128:131] offset:2048
ds_write_b128 v29, v[132:135] offset:3072
ds_write_b128 v29, v[136:139] offset:8192
ds_write_b128 v29, v[140:143] offset:9216
ds_write_b128 v29, v[152:155] offset:28672
ds_write_b128 v29, v[156:159] offset:29696
L_wj_33:
s_mov_b32 s92, 357376
buffer_load_dwordx4 v26, s[36:39], s92 offen offset:3072 lds
s_add_u32 s95, s96, 12288
s_mov_b32 m0, s95
s_mov_b32 s92, 393216
buffer_load_dwordx4 v26, s[36:39], s92 offen offset:0 lds
s_mov_b32 s92, 424960
buffer_load_dwordx4 v26, s[36:39], s92 offen offset:1024 lds
s_mov_b32 s92, 456704
buffer_load_dwordx4 v26, s[36:39], s92 offen offset:2048 lds
s_waitcnt lgkmcnt(0)
s_barrier
ds_read_b128 v[32:35], v4 offset:0
ds_read_b128 v[36:39], v4 offset:1024
ds_read_b128 v[40:43], v4 offset:2048
ds_read_b128 v[44:47], v4 offset:3072
ds_read_b128 v[48:51], v4 offset:4096
ds_read_b128 v[52:55], v4 offset:5120
s_mov_b32 s92, 488448
buffer_load_dwordx4 v26, s[36:39], s92 offen offset:3072 lds
s_add_u32 s95, s96, 16384
s_mov_b32 m0, s95
s_mov_b32 s92, 524288
buffer_load_dwordx4 v26, s[36:39], s92 offen offset:0 lds
s_cmp_eq_u32 s52, 0
s_cbranch_scc1 L_w_34
s_cmp_eq_u32 s52, 1
s_cbranch_scc1 L_w_35
s_cmp_eq_u32 s52, 2
s_cbranch_scc1 L_w_36
s_waitcnt lgkmcnt(0)
v_pk_add_f32 v[32:33], v[32:33], v[152:153]
v_pk_add_f32 v[34:35], v[34:35], v[154:155]
v_pk_add_f32 v[36:37], v[36:37], v[156:157]
v_pk_add_f32 v[38:39], v[38:39], v[158:159]
s_branch L_wj_37
L_w_34:
s_waitcnt lgkmcnt(0)
v_pk_add_f32 v[32:33], v[32:33], v[128:129]
v_pk_add_f32 v[34:35], v[34:35], v[130:131]
v_pk_add_f32 v[36:37], v[36:37], v[132:133]
v_pk_add_f32 v[38:39], v[38:39], v[134:135]
s_branch L_wj_37
L_w_35:
s_waitcnt lgkmcnt(0)
v_pk_add_f32 v[32:33], v[32:33], v[136:137]
v_pk_add_f32 v[34:35], v[34:35], v[138:139]
v_pk_add_f32 v[36:37], v[36:37], v[140:141]
v_pk_add_f32 v[38:39], v[38:39], v[142:143]
s_branch L_wj_37
L_w_36:
s_waitcnt lgkmcnt(0)
v_pk_add_f32 v[32:33], v[32:33], v[144:145]
v_pk_add_f32 v[34:35], v[34:35], v[146:147]
v_pk_add_f32 v[36:37], v[36:37], v[148:149]
v_pk_add_f32 v[38:39], v[38:39], v[150:151]
L_wj_37:
v_pk_add_f32 v[40:41], v[40:41], v[48:49]
v_pk_add_f32 v[42:43], v[42:43], v[50:51]
v_pk_add_f32 v[44:45], v[44:45], v[52:53]
v_pk_add_f32 v[46:47], v[46:47], v[54:55]
s_mov_b32 s92, 556032
buffer_load_dwordx4 v26, s[36:39], s92 offen offset:1024 lds
s_mov_b32 s92, 587776
buffer_load_dwordx4 v26, s[36:39], s92 offen offset:2048 lds
v_pk_add_f32 v[32:33], v[32:33], v[40:41]
v_pk_add_f32 v[34:35], v[34:35], v[42:43]
v_pk_add_f32 v[36:37], v[36:37], v[44:45]
v_pk_add_f32 v[38:39], v[38:39], v[46:47]
s_mov_b32 s92, 619520
buffer_load_dwordx4 v26, s[36:39], s92 offen offset:3072 lds
v_pk_add_f32 v[32:33], v[32:33], v[16:17]
v_pk_add_f32 v[34:35], v[34:35], v[18:19]
v_pk_add_f32 v[36:37], v[36:37], v[20:21]
v_pk_add_f32 v[38:39], v[38:39], v[22:23]
s_mov_b32 s90, 0xc0135761
s_mov_b32 s91, 0xbdd2d3e8
v_mov_b32 v48, s90
v_pk_mul_f32 v[40:41], v[32:33], v[32:33]
v_pk_mul_f32 v[42:43], v[34:35], v[34:35]
v_pk_mul_f32 v[44:45], v[36:37], v[36:37]
v_pk_mul_f32 v[46:47], v[38:39], v[38:39]
v_fma_f32 v40, v40, s91, v48
v_fma_f32 v41, v41, s91, v48
v_fma_f32 v42, v42, s91, v48
v_fma_f32 v43, v43, s91, v48
v_fma_f32 v44, v44, s91, v48
v_fma_f32 v45, v45, s91, v48
v_fma_f32 v46, v46, s91, v48
v_fma_f32 v47, v47, s91, v48
v_pk_mul_f32 v[40:41], v[40:41], v[32:33]
v_pk_mul_f32 v[42:43], v[42:43], v[34:35]
v_pk_mul_f32 v[44:45], v[44:45], v[36:37]
v_pk_mul_f32 v[46:47], v[46:47], v[38:39]
v_exp_f32 v40, v40
v_exp_f32 v41, v41
v_exp_f32 v42, v42
v_exp_f32 v43, v43
v_exp_f32 v44, v44
v_exp_f32 v45, v45
v_exp_f32 v46, v46
v_exp_f32 v47, v47
v_add_f32 v40, 1.0, v40
v_add_f32 v41, 1.0, v41
v_add_f32 v42, 1.0, v42
v_add_f32 v43, 1.0, v43
v_add_f32 v44, 1.0, v44
v_add_f32 v45, 1.0, v45
v_add_f32 v46, 1.0, v46
v_add_f32 v47, 1.0, v47
v_rcp_f32 v40, v40
v_rcp_f32 v41, v41
v_rcp_f32 v42, v42
v_rcp_f32 v43, v43
v_rcp_f32 v44, v44
v_rcp_f32 v45, v45
v_rcp_f32 v46, v46
v_rcp_f32 v47, v47
s_nop 0
v_pk_mul_f32 v[32:33], v[32:33], v[40:41]
v_pk_mul_f32 v[34:35], v[34:35], v[42:43]
v_pk_mul_f32 v[36:37], v[36:37], v[44:45]
v_pk_mul_f32 v[38:39], v[38:39], v[46:47]
v_cvt_pk_bf16_f32 v48, v32, v33
v_cvt_pk_bf16_f32 v49, v34, v35
v_cvt_pk_bf16_f32 v50, v36, v37
v_cvt_pk_bf16_f32 v51, v38, v39
s_nop 1
v_permlane32_swap_b32 v48, v50
v_permlane32_swap_b32 v49, v51
buffer_store_dwordx4 v[48:51], v14, s[48:51], s64 offen sc1
s_add_u32 s95, s96, 20480
s_mov_b32 m0, s95
s_mov_b32 s92, 655360
buffer_load_dwordx4 v26, s[36:39], s92 offen offset:0 lds
s_mov_b32 s92, 687104
buffer_load_dwordx4 v26, s[36:39], s92 offen offset:1024 lds
s_mov_b32 s92, 718848
buffer_load_dwordx4 v26, s[36:39], s92 offen offset:2048 lds
s_mov_b32 s92, 750592
buffer_load_dwordx4 v26, s[36:39], s92 offen offset:3072 lds
s_add_u32 s95, s96, 24576
s_mov_b32 m0, s95
s_mov_b32 s92, 786432
buffer_load_dwordx4 v26, s[36:39], s92 offen offset:0 lds
s_mov_b32 s92, 818176
buffer_load_dwordx4 v26, s[36:39], s92 offen offset:1024 lds
s_mov_b32 s92, 849920
buffer_load_dwordx4 v26, s[36:39], s92 offen offset:2048 lds
s_mov_b32 s92, 881664
buffer_load_dwordx4 v26, s[36:39], s92 offen offset:3072 lds
s_waitcnt vmcnt(8)
s_lshl_b32 s60, s100, 2
s_add_u32 s60, s60, s52
s_mul_i32 s60, s60, 64
s_add_u32 s60, s60, 262144
v_mov_b32 v2, s60
v_mov_b32 v3, s53
s_mov_b64 s[84:85], exec
s_mov_b64 exec, 1
buffer_store_dword v3, v2, s[48:51], 0 offen sc1
s_mov_b64 exec, s[84:85]
ds_read_b64_tr_b16 a[0:1], v24 offset:0
ds_read_b64_tr_b16 a[2:3], v24 offset:512
ds_read_b64_tr_b16 a[4:5], v25 offset:0
ds_read_b64_tr_b16 a[6:7], v25 offset:512
ds_read_b64_tr_b16 a[8:9], v24 offset:2048
ds_read_b64_tr_b16 a[10:11], v24 offset:2560
ds_read_b64_tr_b16 a[12:13], v25 offset:2048
ds_read_b64_tr_b16 a[14:15], v25 offset:2560
ds_read_b64_tr_b16 a[16:17], v24 offset:4096
ds_read_b64_tr_b16 a[18:19], v24 offset:4608
ds_read_b64_tr_b16 a[20:21], v25 offset:4096
ds_read_b64_tr_b16 a[22:23], v25 offset:4608
ds_read_b64_tr_b16 a[24:25], v24 offset:6144
ds_read_b64_tr_b16 a[26:27], v24 offset:6656
ds_read_b64_tr_b16 a[28:29], v25 offset:6144
ds_read_b64_tr_b16 a[30:31], v25 offset:6656
ds_read_b64_tr_b16 a[32:33], v24 offset:8192
ds_read_b64_tr_b16 a[34:35], v24 offset:8704
ds_read_b64_tr_b16 a[36:37], v25 offset:8192
ds_read_b64_tr_b16 a[38:39], v25 offset:8704
ds_read_b64_tr_b16 a[40:41], v24 offset:10240
ds_read_b64_tr_b16 a[42:43], v24 offset:10752
ds_read_b64_tr_b16 a[44:45], v25 offset:10240
ds_read_b64_tr_b16 a[46:47], v25 offset:10752
ds_read_b64_tr_b16 a[48:49], v24 offset:12288
ds_read_b64_tr_b16 a[50:51], v24 offset:12800
ds_read_b64_tr_b16 a[52:53], v25 offset:12288
ds_read_b64_tr_b16 a[54:55], v25 offset:12800
ds_read_b64_tr_b16 a[56:57], v24 offset:14336
ds_read_b64_tr_b16 a[58:59], v24 offset:14848
ds_read_b64_tr_b16 a[60:61], v25 offset:14336
ds_read_b64_tr_b16 a[62:63], v25 offset:14848
ds_read_b64_tr_b16 a[64:65], v24 offset:16384
ds_read_b64_tr_b16 a[66:67], v24 offset:16896
ds_read_b64_tr_b16 a[68:69], v25 offset:16384
ds_read_b64_tr_b16 a[70:71], v25 offset:16896
ds_read_b64_tr_b16 a[72:73], v24 offset:18432
ds_read_b64_tr_b16 a[74:75], v24 offset:18944
ds_read_b64_tr_b16 a[76:77], v25 offset:18432
ds_read_b64_tr_b16 a[78:79], v25 offset:18944
s_waitcnt lgkmcnt(0)
L_nogemm_27:
s_cmp_ge_u32 s56, 28
s_cbranch_scc1 L_nogemm_38
s_cmp_eq_u32 s94, 1
s_cbranch_scc1 L_have_39
v_lshrrev_b32 v26, 3, v1
v_and_b32 v30, 7, v1
v_lshrrev_b32 v31, 2, v1
v_and_b32 v31, 4, v31
v_xor_b32 v30, v30, v31
v_mul_u32_u24 v26, 4096, v26
v_lshl_add_u32 v26, v30, 4, v26
s_mul_i32 s60, s52, 1835008
s_lshl_b32 s61, s93, 7
s_add_u32 s60, s60, s61
v_add_u32 v26, s60, v26
s_add_u32 s95, s96, 0
s_mov_b32 m0, s95
s_mov_b32 s92, 0
buffer_load_dwordx4 v26, s[36:39], s92 offen offset:0 lds
s_mov_b32 s92, 31744
buffer_load_dwordx4 v26, s[36:39], s92 offen offset:1024 lds
s_mov_b32 s92, 63488
buffer_load_dwordx4 v26, s[36:39], s92 offen offset:2048 lds
s_mov_b32 s92, 95232
buffer_load_dwordx4 v26, s[36:39], s92 offen offset:3072 lds
s_add_u32 s95, s96, 4096
s_mov_b32 m0, s95
s_mov_b32 s92, 131072
buffer_load_dwordx4 v26, s[36:39], s92 offen offset:0 lds
s_mov_b32 s92, 162816
buffer_load_dwordx4 v26, s[36:39], s92 offen offset:1024 lds
s_mov_b32 s92, 194560
buffer_load_dwordx4 v26, s[36:39], s92 offen offset:2048 lds
s_mov_b32 s92, 226304
buffer_load_dwordx4 v26, s[36:39], s92 offen offset:3072 lds
s_add_u32 s95, s96, 8192
s_mov_b32 m0, s95
s_mov_b32 s92, 262144
buffer_load_dwordx4 v26, s[36:39], s92 offen offset:0 lds
s_mov_b32 s92, 293888
buffer_load_dwordx4 v26, s[36:39], s92 offen offset:1024 lds
s_mov_b32 s92, 325632
buffer_load_dwordx4 v26, s[36:39], s92 offen offset:2048 lds
s_mov_b32 s92, 357376
buffer_load_dwordx4 v26, s[36:39], s92 offen offset:3072 lds
s_add_u32 s95, s96, 12288
s_mov_b32 m0, s95
s_mov_b32 s92, 393216
buffer_load_dwordx4 v26, s[36:39], s92 offen offset:0 lds
s_mov_b32 s92, 424960
buffer_load_dwordx4 v26, s[36:39], s92 offen offset:1024 lds
s_mov_b32 s92, 456704
buffer_load_dwordx4 v26, s[36:39], s92 offen offset:2048 lds
s_mov_b32 s92, 488448
buffer_load_dwordx4 v26, s[36:39], s92 offen offset:3072 lds
s_add_u32 s95, s96, 16384
s_mov_b32 m0, s95
s_mov_b32 s92, 524288
buffer_load_dwordx4 v26, s[36:39], s92 offen offset:0 lds
s_mov_b32 s92, 556032
buffer_load_dwordx4 v26, s[36:39], s92 offen offset:1024 lds
s_mov_b32 s92, 587776
buffer_load_dwordx4 v26, s[36:39], s92 offen offset:2048 lds
s_mov_b32 s92, 619520
buffer_load_dwordx4 v26, s[36:39], s92 offen offset:3072 lds
s_add_u32 s95, s96, 20480
s_mov_b32 m0, s95
s_mov_b32 s92, 655360
buffer_load_dwordx4 v26, s[36:39], s92 offen offset:0 lds
s_mov_b32 s92, 687104
buffer_load_dwordx4 v26, s[36:39], s92 offen offset:1024 lds
s_mov_b32 s92, 718848
buffer_load_dwordx4 v26, s[36:39], s92 offen offset:2048 lds
s_mov_b32 s92, 750592
buffer_load_dwordx4 v26, s[36:39], s92 offen offset:3072 lds
s_add_u32 s95, s96, 24576
s_mov_b32 m0, s95
s_mov_b32 s92, 786432
buffer_load_dwordx4 v26, s[36:39], s92 offen offset:0 lds
s_mov_b32 s92, 818176
buffer_load_dwordx4 v26, s[36:39], s92 offen offset:1024 lds
s_mov_b32 s92, 849920
buffer_load_dwordx4 v26, s[36:39], s92 offen offset:2048 lds
s_mov_b32 s92, 881664
buffer_load_dwordx4 v26, s[36:39], s92 offen offset:3072 lds
s_waitcnt vmcnt(0)
ds_read_b64_tr_b16 a[0:1], v24 offset:0
ds_read_b64_tr_b16 a[2:3], v24 offset:512
ds_read_b64_tr_b16 a[4:5], v25 offset:0
ds_read_b64_tr_b16 a[6:7], v25 offset:512
ds_read_b64_tr_b16 a[8:9], v24 offset:2048
ds_read_b64_tr_b16 a[10:11], v24 offset:2560
ds_read_b64_tr_b16 a[12:13], v25 offset:2048
ds_read_b64_tr_b16 a[14:15], v25 offset:2560
ds_read_b64_tr_b16 a[16:17], v24 offset:4096
ds_read_b64_tr_b16 a[18:19], v24 offset:4608
ds_read_b64_tr_b16 a[20:21], v25 offset:4096
ds_read_b64_tr_b16 a[22:23], v25 offset:4608
ds_read_b64_tr_b16 a[24:25], v24 offset:6144
ds_read_b64_tr_b16 a[26:27], v24 offset:6656
ds_read_b64_tr_b16 a[28:29], v25 offset:6144
ds_read_b64_tr_b16 a[30:31], v25 offset:6656
ds_read_b64_tr_b16 a[32:33], v24 offset:8192
ds_read_b64_tr_b16 a[34:35], v24 offset:8704
ds_read_b64_tr_b16 a[36:37], v25 offset:8192
ds_read_b64_tr_b16 a[38:39], v25 offset:8704
ds_read_b64_tr_b16 a[40:41], v24 offset:10240
ds_read_b64_tr_b16 a[42:43], v24 offset:10752
ds_read_b64_tr_b16 a[44:45], v25 offset:10240
ds_read_b64_tr_b16 a[46:47], v25 offset:10752
ds_read_b64_tr_b16 a[48:49], v24 offset:12288
ds_read_b64_tr_b16 a[50:51], v24 offset:12800
ds_read_b64_tr_b16 a[52:53], v25 offset:12288
ds_read_b64_tr_b16 a[54:55], v25 offset:12800
ds_read_b64_tr_b16 a[56:57], v24 offset:14336
ds_read_b64_tr_b16 a[58:59], v24 offset:14848
ds_read_b64_tr_b16 a[60:61], v25 offset:14336
ds_read_b64_tr_b16 a[62:63], v25 offset:14848
ds_read_b64_tr_b16 a[64:65], v24 offset:16384
ds_read_b64_tr_b16 a[66:67], v24 offset:16896
ds_read_b64_tr_b16 a[68:69], v25 offset:16384
ds_read_b64_tr_b16 a[70:71], v25 offset:16896
ds_read_b64_tr_b16 a[72:73], v24 offset:18432
ds_read_b64_tr_b16 a[74:75], v24 offset:18944
ds_read_b64_tr_b16 a[76:77], v25 offset:18432
ds_read_b64_tr_b16 a[78:79], v25 offset:18944
s_waitcnt lgkmcnt(0)
L_have_39:
v_min_u32 v3, 27, v1
v_lshrrev_b32 v2, 2, v3
s_mul_i32 s60, s52, 7
v_add_u32 v2, s60, v2
v_mul_u32_u24 v2, 7, v2
v_add_u32 v2, s58, v2
v_lshlrev_b32 v2, 2, v2
v_and_b32 v3, 3, v3
v_add_u32 v2, v2, v3
v_mul_u32_u24 v2, 64, v2
v_add_u32 v2, 262144, v2
s_add_u32 s95, s96, 28672
s_mov_b32 m0, s95
s_mov_b32 s92, 917504
buffer_load_dwordx4 v26, s[36:39], s92 offen offset:0 lds
s_mov_b32 s92, 949248
buffer_load_dwordx4 v26, s[36:39], s92 offen offset:1024 lds
s_mov_b32 s92, 980992
buffer_load_dwordx4 v26, s[36:39], s92 offen offset:2048 lds
v_and_b32 v6, 31, v1
v_lshrrev_b32 v7, 5, v1
v_lshlrev_b32 v3, 4, v1
s_mul_i32 s60, s52, 28672
s_mul_i32 s61, s58, 229376
s_add_u32 s60, s60, s61
s_add_u32 s60, s60, 11534336
v_add_u32 v3, s60, v3
s_mov_b32 s92, 1012736
buffer_load_dwordx4 v26, s[36:39], s92 offen offset:3072 lds
s_add_u32 s95, s96, 0
s_mov_b32 m0, s95
s_mov_b32 s92, 1048576
buffer_load_dwordx4 v26, s[36:39], s92 offen offset:0 lds
s_mov_b32 s92, 1080320
buffer_load_dwordx4 v26, s[36:39], s92 offen offset:1024 lds
s_lshr_b32 s62, s52, 1
s_and_b32 s63, s52, 1
s_lshl_b32 s60, s93, 6
s_lshl_b32 s61, s62, 5
s_add_u32 s60, s60, s61
v_add_u32 v4, s60, v6
v_lshlrev_b32 v5, 1, v4
buffer_load_ushort v10, v5, s[40:43], 0 offen
v_mul_u32_u24 v14, 896, v4
s_lshl_b32 s60, s58, 7
s_lshl_b32 s61, s63, 6
s_add_u32 s60, s60, s61
v_add_u32 v14, s60, v14
v_lshl_add_u32 v14, v7, 4, v14
s_mov_b32 s92, 1112064
buffer_load_dwordx4 v26, s[36:39], s92 offen offset:2048 lds
s_mov_b32 s92, 1143808
buffer_load_dwordx4 v26, s[36:39], s92 offen offset:3072 lds
s_add_u32 s95, s96, 4096
s_mov_b32 m0, s95
s_mov_b32 s92, 1179648
buffer_load_dwordx4 v26, s[36:39], s92 offen offset:0 lds
v_lshrrev_b32 v15, 3, v4
v_mul_u32_u24 v15, 7168, v15
v_bfe_u32 v5, v4, 2, 1
v_mul_u32_u24 v5, 3584, v5
v_add_u32 v15, v15, v5
v_and_b32 v5, 3, v4
v_lshl_add_u32 v15, v5, 2, v15
v_lshl_add_u32 v15, v7, 6, v15
s_lshl_b32 s60, s58, 9
s_lshl_b32 s61, s63, 8
s_add_u32 s60, s60, s61
v_add_u32 v15, s60, v15
s_mov_b32 s92, 1211392
buffer_load_dwordx4 v26, s[36:39], s92 offen offset:1024 lds
s_mov_b32 s92, 1243136
buffer_load_dwordx4 v26, s[36:39], s92 offen offset:2048 lds
s_mov_b32 s92, 1274880
buffer_load_dwordx4 v26, s[36:39], s92 offen offset:3072 lds
v_lshlrev_b32 v4, 4, v1
v_add_u32 v4, 131072, v4
v_mov_b32 v29, v4
s_lshl_b32 s60, s52, 11
v_add_u32 v5, s60, v4
s_lshl_b32 s60, s52, 13
v_add_u32 v4, s60, v4
s_add_u32 s95, s96, 8192
s_mov_b32 m0, s95
s_mov_b32 s92, 1310720
buffer_load_dwordx4 v26, s[36:39], s92 offen offset:0 lds
s_mov_b32 s92, 1342464
buffer_load_dwordx4 v26, s[36:39], s92 offen offset:1024 lds
s_mov_b32 s92, 1374208
buffer_load_dwordx4 v26, s[36:39], s92 offen offset:2048 lds
s_mov_b32 s92, 1405952
buffer_load_dwordx4 v26, s[36:39], s92 offen offset:3072 lds
L_poll_40:
buffer_load_dword v8, v2, s[48:51], 0 offen sc1
s_waitcnt vmcnt(0)
v_cmp_ne_u32 vcc, s53, v8
s_nop 1
s_cbranch_vccz L_pollok_41
s_mov_b64 exec, vcc
s_sub_u32 s54, s54, 1
s_cmp_gt_i32 s54, 0
s_cbranch_scc1 L_poll_40
L_pollok_41:
s_mov_b64 exec, -1
s_or_b32 s60, s2, s52
s_cmp_eq_u32 s60, 0
s_cbranch_scc0 L_noepoch_42
v_mov_b32 v8, 0
v_mov_b32 v9, s53
s_mov_b64 exec, 1
buffer_store_dword v9, v8, s[48:51], 0 offen sc1
s_mov_b64 exec, -1
L_noepoch_42:
s_mov_b32 s101, 0
buffer_load_dwordx4 v[160:163], v3, s[48:51], s101 offen offset:0 sc1
buffer_load_dwordx4 v[164:167], v3, s[48:51], s101 offen offset:1024 sc1
buffer_load_dwordx4 v[168:171], v3, s[48:51], s101 offen offset:2048 sc1
buffer_load_dwordx4 v[172:175], v3, s[48:51], s101 offen offset:3072 sc1
s_mov_b32 s101, 4096
buffer_load_dwordx4 v[176:179], v3, s[48:51], s101 offen offset:0 sc1
buffer_load_dwordx4 v[180:183], v3, s[48:51], s101 offen offset:1024 sc1
buffer_load_dwordx4 v[184:187], v3, s[48:51], s101 offen offset:2048 sc1
buffer_load_dwordx4 v[188:191], v3, s[48:51], s101 offen offset:3072 sc1
s_mov_b32 s101, 8192
buffer_load_dwordx4 v[192:195], v3, s[48:51], s101 offen offset:0 sc1
buffer_load_dwordx4 v[196:199], v3, s[48:51], s101 offen offset:1024 sc1
buffer_load_dwordx4 v[200:203], v3, s[48:51], s101 offen offset:2048 sc1
s_mov_b32 s91, 9437184
ds_read_b64_tr_b16 a[80:81], v24 offset:20480
ds_read_b64_tr_b16 a[82:83], v24 offset:20992
ds_read_b64_tr_b16 a[84:85], v25 offset:20480
ds_read_b64_tr_b16 a[86:87], v25 offset:20992
ds_read_b64_tr_b16 a[88:89], v24 offset:22528
ds_read_b64_tr_b16 a[90:91], v24 offset:23040
ds_read_b64_tr_b16 a[92:93], v25 offset:22528
ds_read_b64_tr_b16 a[94:95], v25 offset:23040
ds_read_b64_tr_b16 a[96:97], v24 offset:24576
ds_read_b64_tr_b16 a[98:99], v24 offset:25088
ds_read_b64_tr_b16 a[100:101], v25 offset:24576
ds_read_b64_tr_b16 a[102:103], v25 offset:25088
ds_read_b64_tr_b16 a[104:105], v24 offset:26624
ds_read_b64_tr_b16 a[106:107], v24 offset:27136
ds_read_b64_tr_b16 a[108:109], v25 offset:26624
ds_read_b64_tr_b16 a[110:111], v25 offset:27136
ds_read_b64_tr_b16 a[112:113], v24 offset:28672
ds_read_b64_tr_b16 a[114:115], v24 offset:29184
ds_read_b64_tr_b16 a[116:117], v25 offset:28672
ds_read_b64_tr_b16 a[118:119], v25 offset:29184
ds_read_b64_tr_b16 a[120:121], v24 offset:30720
ds_read_b64_tr_b16 a[122:123], v24 offset:31232
ds_read_b64_tr_b16 a[124:125], v25 offset:30720
ds_read_b64_tr_b16 a[126:127], v25 offset:31232
ds_read_b64_tr_b16 a[128:129], v24 offset:0
ds_read_b64_tr_b16 a[130:131], v24 offset:512
ds_read_b64_tr_b16 a[132:133], v25 offset:0
ds_read_b64_tr_b16 a[134:135], v25 offset:512
ds_read_b64_tr_b16 a[136:137], v24 offset:2048
ds_read_b64_tr_b16 a[138:139], v24 offset:2560
ds_read_b64_tr_b16 a[140:141], v25 offset:2048
ds_read_b64_tr_b16 a[142:143], v25 offset:2560
ds_read_b64_tr_b16 a[144:145], v24 offset:4096
ds_read_b64_tr_b16 a[146:147], v24 offset:4608
ds_read_b64_tr_b16 a[148:149], v25 offset:4096
ds_read_b64_tr_b16 a[150:151], v25 offset:4608
ds_read_b64_tr_b16 a[152:153], v24 offset:6144
ds_read_b64_tr_b16 a[154:155], v24 offset:6656
ds_read_b64_tr_b16 a[156:157], v25 offset:6144
ds_read_b64_tr_b16 a[158:159], v25 offset:6656
ds_read_b64_tr_b16 a[160:161], v24 offset:8192
ds_read_b64_tr_b16 a[162:163], v24 offset:8704
ds_read_b64_tr_b16 a[164:165], v25 offset:8192
ds_read_b64_tr_b16 a[166:167], v25 offset:8704
ds_read_b64_tr_b16 a[168:169], v24 offset:10240
ds_read_b64_tr_b16 a[170:171], v24 offset:10752
ds_read_b64_tr_b16 a[172:173], v25 offset:10240
ds_read_b64_tr_b16 a[174:175], v25 offset:10752
s_waitcnt lgkmcnt(0)
s_add_u32 s95, s96, 12288
s_mov_b32 m0, s95
s_mov_b32 s92, 1441792
buffer_load_dwordx4 v26, s[36:39], s92 offen offset:0 lds
s_mov_b32 s92, 1473536
buffer_load_dwordx4 v26, s[36:39], s92 offen offset:1024 lds
s_mov_b32 s92, 1505280
buffer_load_dwordx4 v26, s[36:39], s92 offen offset:2048 lds
s_mov_b32 s92, 1537024
buffer_load_dwordx4 v26, s[36:39], s92 offen offset:3072 lds
s_add_u32 s95, s96, 16384
s_mov_b32 m0, s95
s_mov_b32 s92, 1572864
buffer_load_dwordx4 v26, s[36:39], s92 offen offset:0 lds
s_mov_b32 s92, 1604608
buffer_load_dwordx4 v26, s[36:39], s92 offen offset:1024 lds
s_mov_b32 s92, 1636352
buffer_load_dwordx4 v26, s[36:39], s92 offen offset:2048 lds
s_mov_b32 s92, 1668096
buffer_load_dwordx4 v26, s[36:39], s92 offen offset:3072 lds
s_add_u32 s95, s96, 20480
s_mov_b32 m0, s95
s_mov_b32 s92, 1703936
buffer_load_dwordx4 v26, s[36:39], s92 offen offset:0 lds
s_mov_b32 s92, 1735680
buffer_load_dwordx4 v26, s[36:39], s92 offen offset:1024 lds
s_mov_b32 s92, 1767424
buffer_load_dwordx4 v26, s[36:39], s92 offen offset:2048 lds
s_mov_b32 s92, 1799168
buffer_load_dwordx4 v26, s[36:39], s92 offen offset:3072 lds
v_lshlrev_b32 v16, 16, v10
s_waitcnt lgkmcnt(0)
s_waitcnt vmcnt(22)
v_mfma_f32_32x32x16_bf16 v[96:111], v[160:163], a[0:3], 0
v_mfma_f32_32x32x16_bf16 v[112:127], v[160:163], a[4:7], 0
buffer_load_dwordx4 v[160:163], v3, s[48:51], s101 offen offset:3072 sc1
s_waitcnt vmcnt(22)
v_mfma_f32_32x32x16_bf16 v[96:111], v[164:167], a[8:11], v[96:111]
v_mfma_f32_32x32x16_bf16 v[112:127], v[164:167], a[12:15], v[112:127]
s_mov_b32 s101, 12288
buffer_load_dwordx4 v[164:167], v3, s[48:51], s101 offen offset:0 sc1
s_waitcnt vmcnt(22)
v_mfma_f32_32x32x16_bf16 v[96:111], v[168:171], a[16:19], v[96:111]
v_mfma_f32_32x32x16_bf16 v[112:127], v[168:171], a[20:23], v[112:127]
buffer_load_dwordx4 v[168:171], v3, s[48:51], s101 offen offset:1024 sc1
s_waitcnt vmcnt(22)
v_mfma_f32_32x32x16_bf16 v[96:111], v[172:175], a[24:27], v[96:111]
v_mfma_f32_32x32x16_bf16 v[112:127], v[172:175], a[28:31], v[112:127]
buffer_load_dwordx4 v[172:175], v3, s[48:51], s101 offen offset:2048 sc1
s_waitcnt vmcnt(22)
v_mfma_f32_32x32x16_bf16 v[96:111], v[176:179], a[32:35], v[96:111]
v_mfma_f32_32x32x16_bf16 v[112:127], v[176:179], a[36:39], v[112:127]
buffer_load_dwordx4 v[176:179], v3, s[48:51], s101 offen offset:3072 sc1
s_waitcnt vmcnt(22)
v_mfma_f32_32x32x16_bf16 v[96:111], v[180:183], a[40:43], v[96:111]
v_mfma_f32_32x32x16_bf16 v[112:127], v[180:183], a[44:47], v[112:127]
s_mov_b32 s101, 16384
buffer_load_dwordx4 v[180:183], v3, s[48:51], s101 offen offset:0 sc1
s_waitcnt vmcnt(22)
v_mfma_f32_32x32x16_bf16 v[96:111], v[184:187], a[48:51], v[96:111]
v_mfma_f32_32x32x16_bf16 v[112:127], v[184:187], a[52:55], v[112:127]
buffer_load_dwordx4 v[184:187], v3, s[48:51], s101 offen offset:1024 sc1
s_waitcnt vmcnt(22)
v_mfma_f32_32x32x16_bf16 v[96:111], v[188:191], a[56:59], v[96:111]
v_mfma_f32_32x32x16_bf16 v[112:127], v[188:191], a[60:63], v[112:127]
buffer_load_dwordx4 v[188:191], v3, s[48:51], s101 offen offset:2048 sc1
s_waitcnt vmcnt(22)
v_mfma_f32_32x32x16_bf16 v[96:111], v[192:195], a[64:67], v[96:111]
v_mfma_f32_32x32x16_bf16 v[112:127], v[192:195], a[68:71], v[112:127]
buffer_load_dwordx4 v[192:195], v3, s[48:51], s101 offen offset:3072 sc1
s_waitcnt vmcnt(22)
v_mfma_f32_32x32x16_bf16 v[96:111], v[196:199], a[72:75], v[96:111]
v_mfma_f32_32x32x16_bf16 v[112:127], v[196:199], a[76:79], v[112:127]
s_mov_b32 s101, 20480
buffer_load_dwordx4 v[196:199], v3, s[48:51], s101 offen offset:0 sc1
s_waitcnt vmcnt(22)
v_mfma_f32_32x32x16_bf16 v[96:111], v[200:203], a[80:83], v[96:111]
v_mfma_f32_32x32x16_bf16 v[112:127], v[200:203], a[84:87], v[112:127]
buffer_load_dwordx4 v[200:203], v3, s[48:51], s101 offen offset:1024 sc1
s_waitcnt vmcnt(10)
v_mfma_f32_32x32x16_bf16 v[96:111], v[160:163], a[88:91], v[96:111]
v_mfma_f32_32x32x16_bf16 v[112:127], v[160:163], a[92:95], v[112:127]
buffer_load_dwordx4 v[160:163], v3, s[48:51], s101 offen offset:2048 sc1
s_waitcnt vmcnt(10)
v_mfma_f32_32x32x16_bf16 v[96:111], v[164:167], a[96:99], v[96:111]
v_mfma_f32_32x32x16_bf16 v[112:127], v[164:167], a[100:103], v[112:127]
buffer_load_dwordx4 v[164:167], v3, s[48:51], s101 offen offset:3072 sc1
s_waitcnt vmcnt(10)
v_mfma_f32_32x32x16_bf16 v[96:111], v[168:171], a[104:107], v[96:111]
v_mfma_f32_32x32x16_bf16 v[112:127], v[168:171], a[108:111], v[112:127]
s_mov_b32 s101, 24576
buffer_load_dwordx4 v[168:171], v3, s[48:51], s101 offen offset:0 sc1
s_waitcnt vmcnt(10)
v_mfma_f32_32x32x16_bf16 v[96:111], v[172:175], a[112:115], v[96:111]
v_mfma_f32_32x32x16_bf16 v[112:127], v[172:175], a[116:119], v[112:127]
buffer_load_dwordx4 v[172:175], v3, s[48:51], s101 offen offset:1024 sc1
s_waitcnt vmcnt(10)
v_mfma_f32_32x32x16_bf16 v[96:111], v[176:179], a[120:123], v[96:111]
v_mfma_f32_32x32x16_bf16 v[112:127], v[176:179], a[124:127], v[112:127]
buffer_load_dwordx4 v[176:179], v3, s[48:51], s101 offen offset:2048 sc1
s_waitcnt vmcnt(10)
v_mfma_f32_32x32x16_bf16 v[96:111], v[180:183], a[128:131], v[96:111]
v_mfma_f32_32x32x16_bf16 v[112:127], v[180:183], a[132:135], v[112:127]
buffer_load_dwordx4 v[180:183], v3, s[48:51], s101 offen offset:3072 sc1
s_waitcnt vmcnt(10)
v_mfma_f32_32x32x16_bf16 v[96:111], v[184:187], a[136:139], v[96:111]
v_mfma_f32_32x32x16_bf16 v[112:127], v[184:187], a[140:143], v[112:127]
s_mov_b32 s101, 114688
buffer_load_dwordx4 v[184:187], v3, s[48:51], s101 offen offset:0 sc1
s_waitcnt vmcnt(10)
v_mfma_f32_32x32x16_bf16 v[96:111], v[188:191], a[144:147], v[96:111]
v_mfma_f32_32x32x16_bf16 v[112:127], v[188:191], a[148:151], v[112:127]
buffer_load_dwordx4 v[188:191], v3, s[48:51], s101 offen offset:1024 sc1
s_waitcnt vmcnt(19)
ds_read_b64_tr_b16 a[176:177], v24 offset:12288
ds_read_b64_tr_b16 a[178:179], v24 offset:12800
ds_read_b64_tr_b16 a[180:181], v25 offset:12288
ds_read_b64_tr_b16 a[182:183], v25 offset:12800
ds_read_b64_tr_b16 a[184:185], v24 offset:14336
ds_read_b64_tr_b16 a[186:187], v24 offset:14848
ds_read_b64_tr_b16 a[188:189], v25 offset:14336
ds_read_b64_tr_b16 a[190:191], v25 offset:14848
ds_read_b64_tr_b16 a[192:193], v24 offset:16384
ds_read_b64_tr_b16 a[194:195], v24 offset:16896
ds_read_b64_tr_b16 a[196:197], v25 offset:16384
ds_read_b64_tr_b16 a[198:199], v25 offset:16896
ds_read_b64_tr_b16 a[200:201], v24 offset:18432
ds_read_b64_tr_b16 a[202:203], v24 offset:18944
ds_read_b64_tr_b16 a[204:205], v25 offset:18432
ds_read_b64_tr_b16 a[206:207], v25 offset:18944
ds_read_b64_tr_b16 a[208:209], v24 offset:20480
ds_read_b64_tr_b16 a[210:211], v24 offset:20992
ds_read_b64_tr_b16 a[212:213], v25 offset:20480
ds_read_b64_tr_b16 a[214:215], v25 offset:20992
ds_read_b64_tr_b16 a[216:217], v24 offset:22528
ds_read_b64_tr_b16 a[218:219], v24 offset:23040
ds_read_b64_tr_b16 a[220:221], v25 offset:22528
ds_read_b64_tr_b16 a[222:223], v25 offset:23040
s_waitcnt vmcnt(10)
v_mfma_f32_32x32x16_bf16 v[96:111], v[192:195], a[152:155], v[96:111]
v_mfma_f32_32x32x16_bf16 v[112:127], v[192:195], a[156:159], v[112:127]
buffer_load_dwordx4 v[192:195], v3, s[48:51], s101 offen offset:2048 sc1
s_waitcnt vmcnt(10)
v_mfma_f32_32x32x16_bf16 v[96:111], v[196:199], a[160:163], v[96:111]
v_mfma_f32_32x32x16_bf16 v[112:127], v[196:199], a[164:167], v[112:127]
buffer_load_dwordx4 v[196:199], v3, s[48:51], s101 offen offset:3072 sc1
s_waitcnt vmcnt(10)
v_mfma_f32_32x32x16_bf16 v[96:111], v[200:203], a[168:171], v[96:111]
v_mfma_f32_32x32x16_bf16 v[112:127], v[200:203], a[172:175], v[112:127]
s_mov_b32 s101, 118784
buffer_load_dwordx4 v[200:203], v3, s[48:51], s101 offen offset:0 sc1
s_waitcnt lgkmcnt(0)
s_waitcnt vmcnt(10)
v_mfma_f32_32x32x16_bf16 v[96:111], v[160:163], a[176:179], v[96:111]
v_mfma_f32_32x32x16_bf16 v[112:127], v[160:163], a[180:183], v[112:127]
buffer_load_dwordx4 v[160:163], v3, s[48:51], s101 offen offset:1024 sc1
s_waitcnt vmcnt(10)
v_mfma_f32_32x32x16_bf16 v[96:111], v[164:167], a[184:187], v[96:111]
v_mfma_f32_32x32x16_bf16 v[112:127], v[164:167], a[188:191], v[112:127]
buffer_load_dwordx4 v[164:167], v3, s[48:51], s101 offen offset:2048 sc1
s_waitcnt vmcnt(10)
v_mfma_f32_32x32x16_bf16 v[96:111], v[168:171], a[192:195], v[96:111]
v_mfma_f32_32x32x16_bf16 v[112:127], v[168:171], a[196:199], v[112:127]
buffer_load_dwordx4 v[168:171], v3, s[48:51], s101 offen offset:3072 sc1
s_waitcnt vmcnt(10)
v_mfma_f32_32x32x16_bf16 v[96:111], v[172:175], a[200:203], v[96:111]
v_mfma_f32_32x32x16_bf16 v[112:127], v[172:175], a[204:207], v[112:127]
s_mov_b32 s101, 122880
buffer_load_dwordx4 v[172:175], v3, s[48:51], s101 offen offset:0 sc1
s_waitcnt vmcnt(10)
v_mfma_f32_32x32x16_bf16 v[96:111], v[176:179], a[208:211], v[96:111]
v_mfma_f32_32x32x16_bf16 v[112:127], v[176:179], a[212:215], v[112:127]
buffer_load_dwordx4 v[176:179], v3, s[48:51], s101 offen offset:1024 sc1
s_waitcnt vmcnt(10)
v_mfma_f32_32x32x16_bf16 v[96:111], v[180:183], a[216:219], v[96:111]
v_mfma_f32_32x32x16_bf16 v[112:127], v[180:183], a[220:223], v[112:127]
buffer_load_dwordx4 v[180:183], v3, s[48:51], s101 offen offset:2048 sc1
s_waitcnt vmcnt(10)
v_mfma_f32_32x32x16_bf16 v[128:143], v[184:187], a[0:3], 0
v_mfma_f32_32x32x16_bf16 v[144:159], v[184:187], a[4:7], 0
buffer_load_dwordx4 v[184:187], v3, s[48:51], s101 offen offset:3072 sc1
s_waitcnt vmcnt(10)
v_mfma_f32_32x32x16_bf16 v[128:143], v[188:191], a[8:11], v[128:143]
v_mfma_f32_32x32x16_bf16 v[144:159], v[188:191], a[12:15], v[144:159]
s_mov_b32 s101, 126976
buffer_load_dwordx4 v[188:191], v3, s[48:51], s101 offen offset:0 sc1
s_waitcnt vmcnt(10)
v_mfma_f32_32x32x16_bf16 v[128:143], v[192:195], a[16:19], v[128:143]
s_barrier
v_mfma_f32_32x32x16_bf16 v[144:159], v[192:195], a[20:23], v[144:159]
buffer_load_dwordx4 v[192:195], v3, s[48:51], s101 offen offset:1024 sc1
ds_write_b128 v5, v[96:99] offset:0
s_waitcnt vmcnt(10)
v_mfma_f32_32x32x16_bf16 v[128:143], v[196:199], a[24:27], v[128:143]
ds_write_b128 v5, v[100:103] offset:1024
v_mfma_f32_32x32x16_bf16 v[144:159], v[196:199], a[28:31], v[144:159]
buffer_load_dwordx4 v[196:199], v3, s[48:51], s101 offen offset:2048 sc1
ds_write_b128 v5, v[104:107] offset:8192
s_waitcnt vmcnt(10)
v_mfma_f32_32x32x16_bf16 v[128:143], v[200:203], a[32:35], v[128:143]
ds_write_b128 v5, v[108:111] offset:9216
v_mfma_f32_32x32x16_bf16 v[144:159], v[200:203], a[36:39], v[144:159]
buffer_load_dwordx4 v[200:203], v3, s[48:51], s101 offen offset:3072 sc1
ds_write_b128 v5, v[112:115] offset:16384
s_waitcnt vmcnt(10)
v_mfma_f32_32x32x16_bf16 v[128:143], v[160:163], a[40:43], v[128:143]
ds_write_b128 v5, v[116:119] offset:17408
v_mfma_f32_32x32x16_bf16 v[144:159], v[160:163], a[44:47], v[144:159]
s_mov_b32 s101, 131072
buffer_load_dwordx4 v[160:163], v3, s[48:51], s101 offen offset:0 sc1
ds_write_b128 v5, v[120:123] offset:24576
s_waitcnt vmcnt(10)
v_mfma_f32_32x32x16_bf16 v[128:143], v[164:167], a[48:51], v[128:143]
ds_write_b128 v5, v[124:127] offset:25600
v_mfma_f32_32x32x16_bf16 v[144:159], v[164:167], a[52:55], v[144:159]
buffer_load_dwordx4 v[164:167], v3, s[48:51], s101 offen offset:1024 sc1
s_waitcnt lgkmcnt(0)
s_barrier
ds_read_b128 v[32:35], v4 offset:0
s_waitcnt vmcnt(10)
v_mfma_f32_32x32x16_bf16 v[128:143], v[168:171], a[56:59], v[128:143]
ds_read_b128 v[36:39], v4 offset:1024
ds_read_b128 v[40:43], v4 offset:2048
ds_read_b128 v[44:47], v4 offset:3072
v_mfma_f32_32x32x16_bf16 v[144:159], v[168:171], a[60:63], v[144:159]
buffer_load_dwordx4 v[168:171], v3, s[48:51], s101 offen offset:2048 sc1
ds_read_b128 v[48:51], v4 offset:4096
ds_read_b128 v[52:55], v4 offset:5120
ds_read_b128 v[56:59], v4 offset:6144
s_waitcnt vmcnt(10)
v_mfma_f32_32x32x16_bf16 v[128:143], v[172:175], a[64:67], v[128:143]
ds_read_b128 v[60:63], v4 offset:7168
s_waitcnt lgkmcnt(0)
v_add_f32 v32, v32, v40
v_mfma_f32_32x32x16_bf16 v[144:159], v[172:175], a[68:71], v[144:159]
buffer_load_dwordx4 v[172:175], v3, s[48:51], s101 offen offset:3072 sc1
v_add_f32 v33, v33, v41
v_add_f32 v48, v48, v56
v_add_f32 v49, v49, v57
s_waitcnt vmcnt(10)
v_mfma_f32_32x32x16_bf16 v[128:143], v[176:179], a[72:75], v[128:143]
v_add_f32 v34, v34, v42
v_add_f32 v35, v35, v43
v_add_f32 v50, v50, v58
v_mfma_f32_32x32x16_bf16 v[144:159], v[176:179], a[76:79], v[144:159]
s_mov_b32 s101, 135168
buffer_load_dwordx4 v[176:179], v3, s[48:51], s101 offen offset:0 sc1
v_add_f32 v51, v51, v59
v_add_f32 v36, v36, v44
v_add_f32 v37, v37, v45
s_waitcnt vmcnt(10)
v_mfma_f32_32x32x16_bf16 v[128:143], v[180:183], a[80:83], v[128:143]
v_add_f32 v52, v52, v60
v_add_f32 v53, v53, v61
v_add_f32 v38, v38, v46
v_mfma_f32_32x32x16_bf16 v[144:159], v[180:183], a[84:87], v[144:159]
buffer_load_dwordx4 v[180:183], v3, s[48:51], s101 offen offset:1024 sc1
v_add_f32 v39, v39, v47
v_add_f32 v54, v54, v62
v_add_f32 v55, v55, v63
s_waitcnt vmcnt(10)
v_mfma_f32_32x32x16_bf16 v[128:143], v[184:187], a[88:91], v[128:143]
v_add_f32 v64, v32, v48
v_add_f32 v65, v33, v49
v_add_f32 v66, v34, v50
v_mfma_f32_32x32x16_bf16 v[144:159], v[184:187], a[92:95], v[144:159]
buffer_load_dwordx4 v[184:187], v3, s[48:51], s101 offen offset:2048 sc1
v_add_f32 v67, v35, v51
v_add_f32 v68, v36, v52
v_add_f32 v69, v37, v53
s_waitcnt vmcnt(10)
v_mfma_f32_32x32x16_bf16 v[128:143], v[188:191], a[96:99], v[128:143]
v_add_f32 v70, v38, v54
v_add_f32 v71, v39, v55
v_mfma_f32_32x32x16_bf16 v[144:159], v[188:191], a[100:103], v[144:159]
buffer_load_dwordx4 v[188:191], v3, s[48:51], s101 offen offset:3072 sc1
s_waitcnt vmcnt(10)
v_mfma_f32_32x32x16_bf16 v[128:143], v[192:195], a[104:107], v[128:143]
v_mfma_f32_32x32x16_bf16 v[144:159], v[192:195], a[108:111], v[144:159]
s_mov_b32 s101, 139264
buffer_load_dwordx4 v[192:195], v3, s[48:51], s101 offen offset:0 sc1
s_waitcnt vmcnt(10)
v_mfma_f32_32x32x16_bf16 v[128:143], v[196:199], a[112:115], v[128:143]
v_mfma_f32_32x32x16_bf16 v[144:159], v[196:199], a[116:119], v[144:159]
buffer_load_dwordx4 v[196:199], v3, s[48:51], s101 offen offset:1024 sc1
s_waitcnt vmcnt(10)
v_mfma_f32_32x32x16_bf16 v[128:143], v[200:203], a[120:123], v[128:143]
v_mfma_f32_32x32x16_bf16 v[144:159], v[200:203], a[124:127], v[144:159]
buffer_load_dwordx4 v[200:203], v3, s[48:51], s101 offen offset:2048 sc1
s_waitcnt vmcnt(10)
v_mfma_f32_32x32x16_bf16 v[128:143], v[160:163], a[128:131], v[128:143]
v_mfma_f32_32x32x16_bf16 v[144:159], v[160:163], a[132:135], v[144:159]
buffer_load_dwordx4 v[160:163], v3, s[48:51], s101 offen offset:3072 sc1
s_waitcnt vmcnt(10)
v_mfma_f32_32x32x16_bf16 v[128:143], v[164:167], a[136:139], v[128:143]
v_mfma_f32_32x32x16_bf16 v[144:159], v[164:167], a[140:143], v[144:159]
buffer_load_dword v72, v15, s[48:51], s91 offen offset:0 sc1
s_waitcnt vmcnt(10)
v_mfma_f32_32x32x16_bf16 v[128:143], v[168:171], a[144:147], v[128:143]
v_mfma_f32_32x32x16_bf16 v[144:159], v[168:171], a[148:151], v[144:159]
buffer_load_dword v73, v15, s[48:51], s91 offen offset:16 sc1
s_waitcnt vmcnt(10)
v_mfma_f32_32x32x16_bf16 v[128:143], v[172:175], a[152:155], v[128:143]
v_mfma_f32_32x32x16_bf16 v[144:159], v[172:175], a[156:159], v[144:159]
buffer_load_dword v74, v15, s[48:51], s91 offen offset:32 sc1
s_waitcnt vmcnt(10)
v_mfma_f32_32x32x16_bf16 v[128:143], v[176:179], a[160:163], v[128:143]
v_mfma_f32_32x32x16_bf16 v[144:159], v[176:179], a[164:167], v[144:159]
buffer_load_dword v75, v15, s[48:51], s91 offen offset:48 sc1
s_waitcnt vmcnt(10)
v_mfma_f32_32x32x16_bf16 v[128:143], v[180:183], a[168:171], v[128:143]
v_mfma_f32_32x32x16_bf16 v[144:159], v[180:183], a[172:175], v[144:159]
buffer_load_dword v76, v15, s[48:51], s91 offen offset:128 sc1
s_waitcnt vmcnt(10)
v_mfma_f32_32x32x16_bf16 v[128:143], v[184:187], a[176:179], v[128:143]
v_mfma_f32_32x32x16_bf16 v[144:159], v[184:187], a[180:183], v[144:159]
buffer_load_dword v77, v15, s[48:51], s91 offen offset:144 sc1
s_waitcnt vmcnt(10)
v_mfma_f32_32x32x16_bf16 v[128:143], v[188:191], a[184:187], v[128:143]
v_mfma_f32_32x32x16_bf16 v[144:159], v[188:191], a[188:191], v[144:159]
buffer_load_dword v78, v15, s[48:51], s91 offen offset:160 sc1
s_waitcnt vmcnt(10)
v_mfma_f32_32x32x16_bf16 v[128:143], v[192:195], a[192:195], v[128:143]
v_mfma_f32_32x32x16_bf16 v[144:159], v[192:195], a[196:199], v[144:159]
buffer_load_dword v79, v15, s[48:51], s91 offen offset:176 sc1
s_waitcnt vmcnt(10)
v_mfma_f32_32x32x16_bf16 v[128:143], v[196:199], a[200:203], v[128:143]
v_mfma_f32_32x32x16_bf16 v[144:159], v[196:199], a[204:207], v[144:159]
s_waitcnt vmcnt(9)
v_mfma_f32_32x32x16_bf16 v[128:143], v[200:203], a[208:211], v[128:143]
v_mfma_f32_32x32x16_bf16 v[144:159], v[200:203], a[212:215], v[144:159]
s_waitcnt vmcnt(8)
v_mfma_f32_32x32x16_bf16 v[128:143], v[160:163], a[216:219], v[128:143]
v_mfma_f32_32x32x16_bf16 v[144:159], v[160:163], a[220:223], v[144:159]
s_nop 11
s_barrier
s_cmp_eq_u32 s52, 0
s_cbranch_scc1 L_w_43
s_cmp_eq_u32 s52, 1
s_cbranch_scc1 L_w_44
s_cmp_eq_u32 s52, 2
s_cbranch_scc1 L_w_45
ds_write_b128 v29, v[128:131] offset:4096
ds_write_b128 v29, v[132:135] offset:5120
ds_write_b128 v29, v[136:139] offset:10240
ds_write_b128 v29, v[140:143] offset:11264
ds_write_b128 v29, v[144:147] offset:16384
ds_write_b128 v29, v[148:151] offset:17408
s_branch L_wj_46
L_w_43:
ds_write_b128 v29, v[136:139] offset:12288
ds_write_b128 v29, v[140:143] offset:13312
ds_write_b128 v29, v[144:147] offset:18432
ds_write_b128 v29, v[148:151] offset:19456
ds_write_b128 v29, v[152:155] offset:24576
ds_write_b128 v29, v[156:159] offset:25600
s_branch L_wj_46
L_w_44:
ds_write_b128 v29, v[128:131] offset:0
ds_write_b128 v29, v[132:135] offset:1024
ds_write_b128 v29, v[144:147] offset:20480
ds_write_b128 v29, v[148:151] offset:21504
ds_write_b128 v29, v[152:155] offset:26624
ds_write_b128 v29, v[156:159] offset:27648
s_branch L_wj_46
L_w_45:
ds_write_b128 v29, v[128:131] offset:2048
ds_write_b128 v29, v[132:135] offset:3072
ds_write_b128 v29, v[136:139] offset:8192
ds_write_b128 v29, v[140:143] offset:9216
ds_write_b128 v29, v[152:155] offset:28672
ds_write_b128 v29, v[156:159] offset:29696
L_wj_46:
s_waitcnt vmcnt(0)
v_lshlrev_b32 v88, 16, v72
v_and_b32 v80, s66, v72
v_add_f32 v88, v88, v16
v_add_f32 v80, v80, v16
v_add_f32 v64, v64, v88
v_lshlrev_b32 v88, 16, v73
v_and_b32 v81, s66, v73
v_add_f32 v88, v88, v16
v_add_f32 v81, v81, v16
v_add_f32 v65, v65, v88
v_lshlrev_b32 v88, 16, v74
v_and_b32 v82, s66, v74
v_add_f32 v88, v88, v16
v_add_f32 v82, v82, v16
v_add_f32 v66, v66, v88
v_lshlrev_b32 v88, 16, v75
v_and_b32 v83, s66, v75
v_add_f32 v88, v88, v16
v_add_f32 v83, v83, v16
v_add_f32 v67, v67, v88
v_lshlrev_b32 v88, 16, v76
v_and_b32 v84, s66, v76
v_add_f32 v88, v88, v16
v_add_f32 v84, v84, v16
v_add_f32 v68, v68, v88
v_lshlrev_b32 v88, 16, v77
v_and_b32 v85, s66, v77
v_add_f32 v88, v88, v16
v_add_f32 v85, v85, v16
v_add_f32 v69, v69, v88
v_lshlrev_b32 v88, 16, v78
v_and_b32 v86, s66, v78
v_add_f32 v88, v88, v16
v_add_f32 v86, v86, v16
v_add_f32 v70, v70, v88
v_lshlrev_b32 v88, 16, v79
v_and_b32 v87, s66, v79
v_add_f32 v88, v88, v16
v_add_f32 v87, v87, v16
v_add_f32 v71, v71, v88
s_waitcnt lgkmcnt(0)
s_barrier
ds_read_b128 v[32:35], v4 offset:0
ds_read_b128 v[36:39], v4 offset:1024
ds_read_b128 v[40:43], v4 offset:2048
ds_read_b128 v[44:47], v4 offset:3072
ds_read_b128 v[48:51], v4 offset:4096
ds_read_b128 v[52:55], v4 offset:5120
s_cmp_eq_u32 s52, 0
s_cbranch_scc1 L_w_47
s_cmp_eq_u32 s52, 1
s_cbranch_scc1 L_w_48
s_cmp_eq_u32 s52, 2
s_cbranch_scc1 L_w_49
s_waitcnt lgkmcnt(0)
v_pk_add_f32 v[32:33], v[32:33], v[152:153]
v_pk_add_f32 v[34:35], v[34:35], v[154:155]
v_pk_add_f32 v[36:37], v[36:37], v[156:157]
v_pk_add_f32 v[38:39], v[38:39], v[158:159]
s_branch L_wj_50
L_w_47:
s_waitcnt lgkmcnt(0)
v_pk_add_f32 v[32:33], v[32:33], v[128:129]
v_pk_add_f32 v[34:35], v[34:35], v[130:131]
v_pk_add_f32 v[36:37], v[36:37], v[132:133]
v_pk_add_f32 v[38:39], v[38:39], v[134:135]
s_branch L_wj_50
L_w_48:
s_waitcnt lgkmcnt(0)
v_pk_add_f32 v[32:33], v[32:33], v[136:137]
v_pk_add_f32 v[34:35], v[34:35], v[138:139]
v_pk_add_f32 v[36:37], v[36:37], v[140:141]
v_pk_add_f32 v[38:39], v[38:39], v[142:143]
s_branch L_wj_50
L_w_49:
s_waitcnt lgkmcnt(0)
v_pk_add_f32 v[32:33], v[32:33], v[144:145]
v_pk_add_f32 v[34:35], v[34:35], v[146:147]
v_pk_add_f32 v[36:37], v[36:37], v[148:149]
v_pk_add_f32 v[38:39], v[38:39], v[150:151]
L_wj_50:
v_pk_add_f32 v[40:41], v[40:41], v[48:49]
v_pk_add_f32 v[42:43], v[42:43], v[50:51]
v_pk_add_f32 v[44:45], v[44:45], v[52:53]
v_pk_add_f32 v[46:47], v[46:47], v[54:55]
v_pk_add_f32 v[32:33], v[32:33], v[40:41]
v_pk_add_f32 v[34:35], v[34:35], v[42:43]
v_pk_add_f32 v[36:37], v[36:37], v[44:45]
v_pk_add_f32 v[38:39], v[38:39], v[46:47]
v_pk_add_f32 v[32:33], v[32:33], v[80:81]
v_pk_add_f32 v[34:35], v[34:35], v[82:83]
v_pk_add_f32 v[36:37], v[36:37], v[84:85]
v_pk_add_f32 v[38:39], v[38:39], v[86:87]
v_cvt_pk_bf16_f32 v56, v64, v32
v_cvt_pk_bf16_f32 v57, v65, v33
v_cvt_pk_bf16_f32 v58, v66, v34
v_cvt_pk_bf16_f32 v59, v67, v35
v_cvt_pk_bf16_f32 v60, v68, v36
v_cvt_pk_bf16_f32 v61, v69, v37
v_cvt_pk_bf16_f32 v62, v70, v38
v_cvt_pk_bf16_f32 v63, v71, v39
buffer_store_dwordx4 v[56:59], v14, s[44:47], 0 offen offset:0 nt
buffer_store_dwordx4 v[60:63], v14, s[44:47], 0 offen offset:32 nt
L_nogemm_38:
L_exit:
s_endpgm
L_code_end:
.section .rodata,"a"
.p2align 6
.amdhsa_kernel sequential_preLN__ssm_conv_h3__mixer_token_mlp__prompt_kernel
  .amdhsa_next_free_vgpr 512
  .amdhsa_next_free_sgpr 102
  .amdhsa_accum_offset 256
  .amdhsa_group_segment_fixed_size 0
  .amdhsa_kernarg_size 112
  .amdhsa_user_sgpr_count 2
  .amdhsa_user_sgpr_kernarg_segment_ptr 1
  .amdhsa_system_sgpr_workgroup_id_x 1
  .amdhsa_float_denorm_mode_32 3
.end_amdhsa_kernel
```
